```python
import torch

def _softmax(x, axis=-1):
    return torch.softmax(x, dim=axis)
def _gelu(x):
    return torch.nn.functional.gelu(x, approximate="tanh")
def _silu(x):
    return torch.nn.functional.silu(x)
def _sigmoid(x):
    return torch.sigmoid(x)
def _layernorm(x, axis=-1, eps=1e-5):
    m = x.mean(dim=axis, keepdim=True)
    v = x.var(dim=axis, keepdim=True, unbiased=False)
    return (x - m) / torch.sqrt(v + eps)
def _scatter_add(tgt, idx, src, axis=0):
    return tgt.clone().index_add_(axis, idx, src)
def _segment_sum(src, seg, n):
    out = torch.zeros((n,) + src.shape[1:], dtype=src.dtype)
    return out.index_add_(0, seg, src)
def _pad(x, pw):
    flat = tuple(v for pair in reversed(pw) for v in pair)
    return torch.nn.functional.pad(x, flat)

kernel_name = 'standalone__gqa_block_cached__near_ridge'

def setup_inputs():

    _w = (lambda a: (lambda t: t.to(torch.bfloat16) if t.is_floating_point() else t)(torch.as_tensor(a)))
    B, Sq, D = 16, 48, 576
    Hq, Hkv, Sk, Dh = 32, 16, 48, 128
    assert Hq % Hkv == 0, (Hq, Hkv)
    return {
        "x": _w((lambda *s: torch.randn(*s, dtype=torch.bfloat16) * 0.8)(B, Sq, D)),
        "k_cache": _w((lambda *s: torch.randn(*s, dtype=torch.bfloat16) * 0.8)(B, Hkv, Sk, Dh)),
        "v_cache": _w((lambda *s: torch.randn(*s, dtype=torch.bfloat16) * 0.05)(B, Hkv, Sk, Dh)),
        "wq": _w((lambda *s: torch.randn(*s, dtype=torch.bfloat16) * 0.8)(D, Hq * Dh) * (D ** -0.5)),
        "wo": _w((lambda *s: torch.randn(*s, dtype=torch.bfloat16) * 0.05)(Hq * Dh, D) * ((Hq * Dh) ** -0.5)),
    }

def reference(x, k_cache, v_cache, wq, wo):
    B, Sq, D = x.shape
    Hq, Dh = 32, 128
    Hkv = k_cache.shape[1]
    rep = Hq // Hkv
    q = (lambda x, *d: x.permute(*d))((x @ wq).reshape(B, Sq, Hq, Dh), 0, 2, 1, 3)
    k = (lambda x, n, axis: torch.repeat_interleave(x, n, dim=axis))(k_cache, rep, axis=1)
    v = (lambda x, n, axis: torch.repeat_interleave(x, n, dim=axis))(v_cache, rep, axis=1)
    scores = torch.einsum("bhqd,bhkd->bhqk", q, k) * (Dh ** -0.5)
    p = _softmax(scores, axis=-1)
    o = torch.einsum("bhqk,bhkd->bhqd", p, v)
    return (lambda x, *d: x.permute(*d))(o, 0, 2, 1, 3).reshape(B, Sq, Hq * Dh) @ wo
```

```asm
; @launch grid=(256,1,1) block=(512,1,1) lds=159744
.amdgcn_target "amdgcn-amd-amdhsa--gfx950"
.text
.p2align 12
.fill 832, 4, 0xbf800000
.globl standalone__gqa_block_cached__near_ridge_kernel
.p2align 8
.type standalone__gqa_block_cached__near_ridge_kernel,@function
standalone__gqa_block_cached__near_ridge_kernel:
    s_cmp_ge_u32 s2, 256
    s_cbranch_scc1 L_end1
    s_load_dwordx2 s[4:5], s[0:1], 0
    s_load_dwordx2 s[16:17], s[0:1], 24
    v_lshrrev_b32 v24, 6, v0
    v_and_b32 v0, 63, v0
    s_and_b32 s37, s2, 7
    s_bfe_u32 s38, s2, 0x20003
    s_lshr_b32 s39, s2, 5
    v_readfirstlane_b32 s36, v24
    s_nop 1
    s_and_b32 s40, s36, 1
    s_bfe_u32 s41, s36, 0x10001
    s_cmp_lt_u32 s36, 4
    s_cbranch_scc0 L_stream
    s_getpc_b64 s[92:93]
L_pc0:
    s_lshr_b32 s42, s2, 3
    s_lshl_b32 s42, s42, 2
    s_add_u32 s42, s42, s36
    s_mul_i32 s42, s42, 192
    s_min_u32 s42, s42, L_code_end - L_pc0 - 192
    s_add_u32 s92, s92, s42
    s_addc_u32 s93, s93, 0
    s_load_dword s61, s[92:93], 0
    s_load_dword s61, s[92:93], 64
    s_load_dword s61, s[92:93], 128
    s_branch L_compute
L_stream:
    s_setprio 1
    s_add_u32 s88, s38, s39
    s_mul_i32 s43, s88, 43
    s_lshr_b32 s43, s43, 7
    s_mul_i32 s43, s43, 3
    s_sub_u32 s88, s88, s43
    v_lshrrev_b32 v24, 3, v0
    v_and_b32 v25, 7, v0
    s_and_b32 s51, s36, 3
    s_mul_i32 s89, s88, 384
    s_lshl_b32 s46, s89, 12
    s_mul_i32 s90, s51, 3072
    s_lshl_b32 s47, s51, 12
    s_mov_b32 s6, 884736
    s_mov_b32 s7, 0x00020000
    s_mov_b32 s18, 4718592
    s_mov_b32 s19, 0x00020000
    v_and_b32 v26, 2, v24
    v_xor_b32 v26, v26, v25
    v_lshlrev_b32 v26, 4, v26
    s_mul_i32 s91, s38, 9
    s_and_b32 s91, s91, 17
    s_lshl1_add_u32 s91, s37, s91
    s_lshl_b32 s42, s91, 1
    s_add_u32 s42, s42, s40
    s_lshl_b32 s42, s42, 7
    s_lshl_b32 s43, s41, 18
    s_add_u32 s42, s42, s43
    v_lshlrev_b32 v27, 13, v24
    v_add3_u32 v36, v26, v27, s42
    v_xor_b32 v37, 64, v36
    v_add_u32 v38, 129024, v36
    v_add_u32 v39, 193536, v37
    v_add_u32 v37, 64512, v37
    s_lshl_b32 s43, s40, 2
    v_lshrrev_b32 v28, 1, v24
    v_or_b32 v28, s43, v28
    v_xor_b32 v28, v28, v25
    v_lshlrev_b32 v28, 4, v28
    s_lshl_b32 s42, s39, 2
    s_add_u32 s42, s42, s51
    s_mul_i32 s42, s42, 27648
    v_mul_u32_u24 v27, 1152, v24
    v_add3_u32 v32, v28, v27, s42
    v_xor_b32 v33, 64, v32
    v_add_u32 v34, 16384, v32
    v_add_u32 v33, 8192, v33
    s_waitcnt lgkmcnt(0)
    s_add_u32 m0, s47, 110592
    s_nop 0
    buffer_load_dwordx4 v36, s[16:19], s46 offen offset:0 lds
    buffer_load_dwordx4 v37, s[16:19], s46 offen offset:1024 lds
    buffer_load_dwordx4 v38, s[16:19], s46 offen offset:2048 lds
    buffer_load_dwordx4 v39, s[16:19], s46 offen offset:3072 lds
    s_add_u32 m0, s90, 73728
    s_nop 0
    buffer_load_dwordx4 v32, s[4:7], s89 offen offset:0 lds
    buffer_load_dwordx4 v33, s[4:7], s89 offen offset:1024 lds
    buffer_load_dwordx4 v34, s[4:7], s89 offen offset:2048 lds
    s_add_u32 s89, s89, 128
    s_lshl_b32 s46, s89, 12
    s_load_dwordx2 s[8:9], s[0:1], 8
    s_load_dwordx2 s[12:13], s[0:1], 16
    s_load_dwordx2 s[20:21], s[0:1], 32
    s_load_dwordx2 s[24:25], s[0:1], 56
    s_load_dwordx2 s[28:29], s[0:1], 40
    s_load_dwordx2 s[32:33], s[0:1], 48
    s_mov_b32 s10, 3145728
    s_mov_b32 s11, 0x00020000
    s_mov_b32 s14, 3145728
    s_mov_b32 s15, 0x00020000
    s_mov_b32 s22, 4718592
    s_mov_b32 s23, 0x00020000
    s_mov_b32 s26, 268435456
    s_mov_b32 s27, 0x00020000
    s_mov_b32 s30, 884736
    s_mov_b32 s31, 0x00020000
    s_mov_b32 s34, 256
    s_mov_b32 s35, 0x00020000
    s_mul_i32 s50, s39, 1576960
    s_lshl_b32 s42, s39, 1
    s_add_u32 s42, s42, s40
    s_lshl_b32 s42, s42, 4
    s_lshr_b32 s43, s91, 1
    s_add_u32 s42, s42, s43
    s_mul_i32 s62, s42, 12288
    s_xor_b32 s42, s42, 8
    s_mul_i32 s49, s42, 12288
    s_mul_i32 s63, s40, 12288
    v_lshrrev_b32 v28, 4, v0
    v_and_b32 v29, 15, v0
    v_xor_b32 v29, v29, v28
    v_lshlrev_b32 v29, 4, v29
    v_lshl_add_u32 v40, v28, 8, v29
    v_xor_b32 v41, 64, v40
    v_xor_b32 v42, 128, v40
    v_xor_b32 v43, 192, v40
    s_mul_i32 s42, s51, 3
    s_add_u32 s43, s42, 0
    s_and_b32 s43, s43, 3
    s_lshl_b32 s43, s43, 6
    v_xor_b32 v44, s43, v40
    s_add_u32 s43, s42, 1
    s_and_b32 s43, s43, 3
    s_lshl_b32 s43, s43, 6
    v_xor_b32 v45, s43, v40
    s_add_u32 s43, s42, 2
    s_and_b32 s43, s43, 3
    s_lshl_b32 s43, s43, 6
    v_xor_b32 v46, s43, v40
    s_lshl_b32 s42, s42, 10
    s_and_b32 s43, s38, 1
    s_mul_i32 s86, s43, 12288
    s_add_u32 s86, s86, s42
    s_xor_b32 s44, s43, 1
    s_mul_i32 s87, s44, 12288
    s_add_u32 s87, s87, s42
    s_mul_i32 s84, s40, 196608
    s_sub_u32 s84, s62, s84
    s_add_u32 s84, s84, s42
    s_mul_i32 s44, s44, 196608
    s_add_u32 s85, s84, s44
    s_mul_i32 s43, s43, 196608
    s_add_u32 s84, s84, s43
    s_and_b32 s88, s39, 1
    s_add_u32 s88, s88, 4
    v_lshrrev_b32 v60, 1, v0
    v_lshlrev_b32 v60, 10, v60
    v_and_b32 v61, 1, v0
    v_lshl_add_u32 v60, v61, 4, v60
    v_mov_b32 v61, 1
    s_or_b32 s83, s38, s51
    v_mov_b32 v56, 0
    v_mov_b32 v57, 0
    v_mov_b32 v58, 0
    v_mov_b32 v59, 0
    v_add_u32 v48, v26, v27
    v_xor_b32 v49, 64, v48
    v_add_u32 v50, 16384, v48
    v_add_u32 v51, 24576, v49
    v_add_u32 v49, 8192, v49
    v_bfe_u32 v26, v0, 4, 1
    v_mul_u32_u24 v26, 16, v26
    v_and_or_b32 v26, v24, 1, v26
    v_xor_b32 v26, s91, v26
    v_cmp_lt_u32 vcc, 31, v0
    v_mov_b32 v28, s91
    s_nop 0
    v_cndmask_b32 v26, v26, v28, vcc
    v_lshl_add_u32 v26, v26, 7, v25
    v_mul_u32_u24 v26, 1152, v26
    s_lshl_b32 s43, s38, 1
    s_add_u32 s43, s43, s40
    s_lshl_b32 s43, s43, 7
    v_mov_b32 v28, s43
    v_mov_b32 v29, 1024
    v_cndmask_b32 v28, v28, v29, vcc
    v_add_u32 v52, v26, v28
    s_lshl_b32 s42, s39, 1
    s_add_u32 s42, s42, s41
    s_mul_i32 s52, s42, 9216
    s_mul_i32 s48, s40, 3
    v_lshrrev_b32 v26, 4, v0
    v_and_b32 v27, 15, v0
    v_lshlrev_b32 v1, 4, v0
    s_lshl_b32 s42, s48, 12
    v_lshlrev_b32 v28, 3, v0
    v_add_u32 v2, s42, v28
    s_mul_i32 s42, s48, 1536
    s_add_u32 s42, s42, 101376
    v_add_u32 v4, s42, v1
    v_add_u32 v5, s42, v28
    s_lshl_b32 s55, s37, 2
    s_add_u32 s55, s55, s38
    s_mul_i32 s55, s55, 9216
    s_add_u32 s55, s55, s50
    s_add_u32 s55, s55, 1024
    s_cmp_ge_u32 s48, 3
    s_cselect_b32 s43, 12288, 0
    s_add_u32 s43, s43, 24576
    v_xor_b32 v28, v26, v27
    v_lshlrev_b32 v28, 4, v28
    v_lshl_add_u32 v28, v27, 8, v28
    v_xor_b32 v20, 0, v28
    v_add_u32 v20, s43, v20
    v_xor_b32 v21, 64, v28
    v_add_u32 v21, s43, v21
    v_xor_b32 v22, 128, v28
    v_add_u32 v22, s43, v22
    v_xor_b32 v23, 192, v28
    v_add_u32 v23, s43, v23
    s_mov_b32 s100, 0x3e0293ee
    s_mov_b32 s101, 0xbe0293ee
    s_waitcnt lgkmcnt(0)
    s_add_u32 m0, s47, 126976
    s_nop 0
    buffer_load_dwordx4 v36, s[16:19], s46 offen offset:0 lds
    buffer_load_dwordx4 v37, s[16:19], s46 offen offset:1024 lds
    buffer_load_dwordx4 v38, s[16:19], s46 offen offset:2048 lds
    buffer_load_dwordx4 v39, s[16:19], s46 offen offset:3072 lds
    s_add_u32 m0, s90, 86016
    s_nop 0
    buffer_load_dwordx4 v32, s[4:7], s89 offen offset:0 lds
    buffer_load_dwordx4 v33, s[4:7], s89 offen offset:1024 lds
    buffer_load_dwordx4 v34, s[4:7], s89 offen offset:2048 lds
    s_add_u32 s89, s89, 128
    s_lshl_b32 s46, s89, 12
    s_mov_b32 s60, 0
    s_mov_b32 s45, 32768
    s_mov_b32 s44, 24576
    s_add_u32 s47, s47, 110592
    s_add_u32 s90, s90, 73728
L_sloop:
    s_add_u32 m0, s47, s45
    s_waitcnt vmcnt(7)
    s_barrier
    buffer_load_dwordx4 v36, s[16:19], s46 offen offset:0 lds
    s_add_u32 s43, s89, 128
    s_cmp_eq_u32 s43, 1152
    s_cselect_b32 s43, 0, s43
    buffer_load_dwordx4 v37, s[16:19], s46 offen offset:1024 lds
    s_add_u32 s60, s60, 1
    s_add_u32 s45, s45, 16384
    buffer_load_dwordx4 v38, s[16:19], s46 offen offset:2048 lds
    buffer_load_dwordx4 v39, s[16:19], s46 offen offset:3072 lds
    s_add_u32 m0, s90, s44
    s_lshl_b32 s46, s43, 12
    buffer_load_dwordx4 v32, s[4:7], s89 offen offset:0 lds
    s_add_u32 s44, s44, 12288
    s_cmp_eq_u32 s45, 49152
    s_cselect_b32 s45, 0, s45
    s_cselect_b32 s44, 0, s44
    buffer_load_dwordx4 v33, s[4:7], s89 offen offset:1024 lds
    s_cmp_eq_u32 s88, s60
    buffer_load_dwordx4 v34, s[4:7], s89 offen offset:2048 lds
    s_mov_b32 s89, s43
    s_cbranch_scc1 L_win
L_winback:
    s_cmp_lt_u32 s60, 7
    s_cbranch_scc1 L_sloop
    s_branch L_sdone
L_win:
    s_add_u32 m0, s86, 24576
    s_nop 0
    buffer_load_dwordx4 v44, s[8:11], s84 offen offset:0 lds
    buffer_load_dwordx4 v45, s[8:11], s84 offen offset:1024 lds
    buffer_load_dwordx4 v46, s[8:11], s84 offen offset:2048 lds
    s_add_u32 m0, s86, 49152
    s_nop 0
    buffer_load_dwordx4 v44, s[12:15], s84 offen offset:0 lds
    buffer_load_dwordx4 v45, s[12:15], s84 offen offset:1024 lds
    buffer_load_dwordx4 v46, s[12:15], s84 offen offset:2048 lds
    s_cmp_lg_u32 s83, 0
    s_cbranch_scc1 L_winback
    s_lshl_b32 s42, s37, 7
    s_add_u32 s42, s42, s50
    s_mov_b64 exec, 0xfff
    buffer_store_dwordx4 v[56:59], v60, s[24:27], s42 offen sc1
    s_mov_b64 exec, -1
    s_branch L_winback
L_sdone:
    s_waitcnt vmcnt(7)
    s_barrier
    s_add_u32 m0, s87, 24576
    s_nop 0
    buffer_load_dwordx4 v44, s[8:11], s85 offen offset:0 lds
    buffer_load_dwordx4 v45, s[8:11], s85 offen offset:1024 lds
    buffer_load_dwordx4 v46, s[8:11], s85 offen offset:2048 lds
    s_add_u32 m0, s87, 49152
    s_nop 0
    buffer_load_dwordx4 v44, s[12:15], s85 offen offset:0 lds
    buffer_load_dwordx4 v45, s[12:15], s85 offen offset:1024 lds
    buffer_load_dwordx4 v46, s[12:15], s85 offen offset:2048 lds
    s_waitcnt vmcnt(6)
    s_barrier
    buffer_load_dword v53, v52, s[20:23], s52 offen
    s_setprio 0
    s_cmp_eq_u32 s41, 0
    s_cbranch_scc1 L_helper
    s_lshl_b32 s47, s40, 12
    s_lshl_b32 s43, s38, 1
    s_add_u32 s43, s43, s40
    s_lshl_b32 s43, s43, 7
    s_xor_b32 s42, s91, 0
    s_mul_i32 s42, s42, 147456
    s_add_u32 s56, s42, s43
    s_xor_b32 s42, s91, 1
    s_mul_i32 s42, s42, 147456
    s_add_u32 s57, s42, s43
    s_xor_b32 s42, s91, 16
    s_mul_i32 s42, s42, 147456
    s_add_u32 s58, s42, s43
    s_xor_b32 s42, s91, 17
    s_mul_i32 s42, s42, 147456
    s_add_u32 s59, s42, s43
    s_lshl_b32 s42, s91, 2
    s_add_u32 s42, s42, s40
    s_mul_i32 s42, s42, 36864
    s_add_u32 s51, s42, 1024
    s_waitcnt vmcnt(4)
    s_barrier
    s_add_u32 m0, s47, 73728
    s_add_u32 s42, s51, 0
    buffer_load_dwordx4 v48, s[20:23], s42 offen offset:0 lds
    buffer_load_dwordx4 v49, s[20:23], s42 offen offset:1024 lds
    buffer_load_dwordx4 v50, s[20:23], s42 offen offset:2048 lds
    buffer_load_dwordx4 v51, s[20:23], s42 offen offset:3072 lds
    s_waitcnt vmcnt(5)
    s_barrier
    s_add_u32 m0, s47, 81920
    s_add_u32 s42, s51, 73728
    buffer_load_dwordx4 v48, s[20:23], s42 offen offset:0 lds
    buffer_load_dwordx4 v49, s[20:23], s42 offen offset:1024 lds
    buffer_load_dwordx4 v50, s[20:23], s42 offen offset:2048 lds
    buffer_load_dwordx4 v51, s[20:23], s42 offen offset:3072 lds
    s_add_u32 m0, s47, 110592
    s_add_u32 s42, s56, 0
    buffer_load_dwordx4 v48, s[20:23], s42 offen offset:0 lds
    buffer_load_dwordx4 v49, s[20:23], s42 offen offset:1024 lds
    buffer_load_dwordx4 v50, s[20:23], s42 offen offset:2048 lds
    buffer_load_dwordx4 v51, s[20:23], s42 offen offset:3072 lds
    s_add_u32 m0, s47, 118784
    s_add_u32 s42, s56, 36864
    buffer_load_dwordx4 v48, s[20:23], s42 offen offset:0 lds
    buffer_load_dwordx4 v49, s[20:23], s42 offen offset:1024 lds
    buffer_load_dwordx4 v50, s[20:23], s42 offen offset:2048 lds
    buffer_load_dwordx4 v51, s[20:23], s42 offen offset:3072 lds
    s_add_u32 m0, s47, 126976
    s_add_u32 s42, s56, 73728
    buffer_load_dwordx4 v48, s[20:23], s42 offen offset:0 lds
    buffer_load_dwordx4 v49, s[20:23], s42 offen offset:1024 lds
    buffer_load_dwordx4 v50, s[20:23], s42 offen offset:2048 lds
    buffer_load_dwordx4 v51, s[20:23], s42 offen offset:3072 lds
    s_add_u32 m0, s47, 135168
    s_add_u32 s42, s56, 110592
    buffer_load_dwordx4 v48, s[20:23], s42 offen offset:0 lds
    buffer_load_dwordx4 v49, s[20:23], s42 offen offset:1024 lds
    buffer_load_dwordx4 v50, s[20:23], s42 offen offset:2048 lds
    buffer_load_dwordx4 v51, s[20:23], s42 offen offset:3072 lds
    s_waitcnt vmcnt(16)
    s_barrier
    v_and_b32 v26, 3, v0
    v_lshlrev_b32 v26, 2, v26
    v_add_u32 v27, 1024, v26
    s_mul_i32 s52, s37, 36864
    s_add_u32 s52, s52, s50
    s_add_u32 s52, s52, s47
    s_add_u32 s52, s52, 102400
    s_lshl_b32 s54, s37, 7
    s_add_u32 s54, s54, s50
    s_add_u32 m0, s47, 143360
    s_add_u32 s42, s57, 0
    buffer_load_dwordx4 v48, s[20:23], s42 offen offset:0 lds
    buffer_load_dwordx4 v49, s[20:23], s42 offen offset:1024 lds
    buffer_load_dwordx4 v50, s[20:23], s42 offen offset:2048 lds
    buffer_load_dwordx4 v51, s[20:23], s42 offen offset:3072 lds
    s_add_u32 m0, s47, 151552
    s_add_u32 s42, s57, 36864
    buffer_load_dwordx4 v48, s[20:23], s42 offen offset:0 lds
    buffer_load_dwordx4 v49, s[20:23], s42 offen offset:1024 lds
    buffer_load_dwordx4 v50, s[20:23], s42 offen offset:2048 lds
    buffer_load_dwordx4 v51, s[20:23], s42 offen offset:3072 lds
    s_waitcnt vmcnt(16)
    s_barrier
    s_add_u32 m0, s47, 24576
    s_add_u32 s42, s57, 73728
    buffer_load_dwordx4 v48, s[20:23], s42 offen offset:0 lds
    buffer_load_dwordx4 v49, s[20:23], s42 offen offset:1024 lds
    buffer_load_dwordx4 v50, s[20:23], s42 offen offset:2048 lds
    buffer_load_dwordx4 v51, s[20:23], s42 offen offset:3072 lds
    s_add_u32 m0, s47, 32768
    s_add_u32 s42, s57, 110592
    buffer_load_dwordx4 v48, s[20:23], s42 offen offset:0 lds
    buffer_load_dwordx4 v49, s[20:23], s42 offen offset:1024 lds
    buffer_load_dwordx4 v50, s[20:23], s42 offen offset:2048 lds
    buffer_load_dwordx4 v51, s[20:23], s42 offen offset:3072 lds
    s_add_u32 m0, s63, 49152
    s_add_u32 s42, s49, 0
    buffer_load_dwordx4 v40, s[12:15], s42 offen offset:0 lds
    buffer_load_dwordx4 v41, s[12:15], s42 offen offset:1024 lds
    buffer_load_dwordx4 v42, s[12:15], s42 offen offset:2048 lds
    buffer_load_dwordx4 v43, s[12:15], s42 offen offset:3072 lds
    s_add_u32 m0, s63, 53248
    s_add_u32 s42, s49, 4096
    buffer_load_dwordx4 v40, s[12:15], s42 offen offset:0 lds
    buffer_load_dwordx4 v41, s[12:15], s42 offen offset:1024 lds
    buffer_load_dwordx4 v42, s[12:15], s42 offen offset:2048 lds
    buffer_load_dwordx4 v43, s[12:15], s42 offen offset:3072 lds
    s_waitcnt vmcnt(24)
    s_barrier
    s_add_u32 m0, s63, 57344
    s_add_u32 s42, s49, 8192
    buffer_load_dwordx4 v40, s[12:15], s42 offen offset:0 lds
    buffer_load_dwordx4 v41, s[12:15], s42 offen offset:1024 lds
    buffer_load_dwordx4 v42, s[12:15], s42 offen offset:2048 lds
    buffer_load_dwordx4 v43, s[12:15], s42 offen offset:3072 lds
    s_add_u32 m0, s47, 40960
    s_add_u32 s42, s58, 0
    buffer_load_dwordx4 v48, s[20:23], s42 offen offset:0 lds
    buffer_load_dwordx4 v49, s[20:23], s42 offen offset:1024 lds
    buffer_load_dwordx4 v50, s[20:23], s42 offen offset:2048 lds
    buffer_load_dwordx4 v51, s[20:23], s42 offen offset:3072 lds
    s_add_u32 m0, s47, 0
    s_add_u32 s42, s58, 36864
    buffer_load_dwordx4 v48, s[20:23], s42 offen offset:0 lds
    buffer_load_dwordx4 v49, s[20:23], s42 offen offset:1024 lds
    buffer_load_dwordx4 v50, s[20:23], s42 offen offset:2048 lds
    buffer_load_dwordx4 v51, s[20:23], s42 offen offset:3072 lds
    s_add_u32 m0, s47, 8192
    s_add_u32 s42, s58, 73728
    buffer_load_dwordx4 v48, s[20:23], s42 offen offset:0 lds
    buffer_load_dwordx4 v49, s[20:23], s42 offen offset:1024 lds
    buffer_load_dwordx4 v50, s[20:23], s42 offen offset:2048 lds
    buffer_load_dwordx4 v51, s[20:23], s42 offen offset:3072 lds
    s_waitcnt vmcnt(24)
    s_barrier
    s_add_u32 m0, s47, 16384
    s_add_u32 s42, s58, 110592
    buffer_load_dwordx4 v48, s[20:23], s42 offen offset:0 lds
    buffer_load_dwordx4 v49, s[20:23], s42 offen offset:1024 lds
    buffer_load_dwordx4 v50, s[20:23], s42 offen offset:2048 lds
    buffer_load_dwordx4 v51, s[20:23], s42 offen offset:3072 lds
    s_add_u32 m0, s47, 110592
    s_add_u32 s42, s59, 0
    buffer_load_dwordx4 v48, s[20:23], s42 offen offset:0 lds
    buffer_load_dwordx4 v49, s[20:23], s42 offen offset:1024 lds
    buffer_load_dwordx4 v50, s[20:23], s42 offen offset:2048 lds
    buffer_load_dwordx4 v51, s[20:23], s42 offen offset:3072 lds
    s_add_u32 m0, s47, 118784
    s_add_u32 s42, s59, 36864
    buffer_load_dwordx4 v48, s[20:23], s42 offen offset:0 lds
    buffer_load_dwordx4 v49, s[20:23], s42 offen offset:1024 lds
    buffer_load_dwordx4 v50, s[20:23], s42 offen offset:2048 lds
    buffer_load_dwordx4 v51, s[20:23], s42 offen offset:3072 lds
    buffer_load_dword v24, v26, s[24:27], s54 offen sc1
    s_add_u32 m0, s47, 126976
    s_add_u32 s42, s59, 73728
    buffer_load_dwordx4 v48, s[20:23], s42 offen offset:0 lds
    buffer_load_dwordx4 v49, s[20:23], s42 offen offset:1024 lds
    buffer_load_dwordx4 v50, s[20:23], s42 offen offset:2048 lds
    buffer_load_dwordx4 v51, s[20:23], s42 offen offset:3072 lds
    s_add_u32 m0, s47, 135168
    s_add_u32 s42, s59, 110592
    buffer_load_dwordx4 v48, s[20:23], s42 offen offset:0 lds
    buffer_load_dwordx4 v49, s[20:23], s42 offen offset:1024 lds
    buffer_load_dwordx4 v50, s[20:23], s42 offen offset:2048 lds
    buffer_load_dwordx4 v51, s[20:23], s42 offen offset:3072 lds
    s_waitcnt vmcnt(17)
    s_barrier
    s_waitcnt vmcnt(8)
    v_cmp_gt_u32 vcc, 1, v24
    s_cbranch_vccz L_g_ok
    s_mov_b32 s60, 0
L_g:
    buffer_load_dword v24, v26, s[24:27], s54 offen sc1
    s_cmp_lt_u32 s60, 12
    s_cbranch_scc1 L_g_f
    buffer_load_dword v25, v27, s[24:27], s54 offen sc1
    s_waitcnt vmcnt(0)
    v_max_u32 v24, v24, v25
L_g_f:
    s_waitcnt vmcnt(0)
    v_cmp_gt_u32 vcc, 1, v24
    s_cbranch_vccz L_g_ok
    s_add_u32 s60, s60, 1
    s_cmp_lt_u32 s60, 0x40000
    s_cbranch_scc1 L_g
L_g_ok:
    s_xor_b32 s42, s38, 1
    s_mul_i32 s42, s42, 9216
    s_add_u32 s42, s42, s52
    s_add_u32 m0, s47, 92160
    s_nop 0
    buffer_load_dwordx4 v1, s[24:27], s42 offen offset:0 sc1 lds
    buffer_load_dwordx4 v1, s[24:27], s42 offen offset:1024 sc1 lds
    buffer_load_dwordx4 v1, s[24:27], s42 offen offset:2048 sc1 lds
    buffer_load_dwordx4 v1, s[24:27], s42 offen offset:3072 sc1 lds
    s_waitcnt vmcnt(4)
    s_barrier
    s_xor_b32 s42, s38, 2
    s_mul_i32 s42, s42, 9216
    s_add_u32 s42, s42, s52
    s_add_u32 m0, s47, 82944
    s_nop 0
    buffer_load_dwordx4 v1, s[24:27], s42 offen offset:0 sc1 lds
    buffer_load_dwordx4 v1, s[24:27], s42 offen offset:1024 sc1 lds
    buffer_load_dwordx4 v1, s[24:27], s42 offen offset:2048 sc1 lds
    buffer_load_dwordx4 v1, s[24:27], s42 offen offset:3072 sc1 lds
    s_xor_b32 s42, s38, 3
    s_mul_i32 s42, s42, 9216
    s_add_u32 s42, s42, s52
    s_add_u32 m0, s47, 73728
    s_nop 0
    buffer_load_dwordx4 v1, s[24:27], s42 offen offset:0 sc1 lds
    buffer_load_dwordx4 v1, s[24:27], s42 offen offset:1024 sc1 lds
    buffer_load_dwordx4 v1, s[24:27], s42 offen offset:2048 sc1 lds
    buffer_load_dwordx4 v1, s[24:27], s42 offen offset:3072 sc1 lds
    s_cmp_eq_u32 s40, 0
    s_cbranch_scc1 L_g4
    s_xor_b32 s42, s38, 1
    s_mul_i32 s42, s42, 9216
    s_add_u32 s42, s42, s52
    s_add_u32 s42, s42, 4096
    s_mov_b32 m0, 100352
    s_nop 0
    buffer_load_dwordx4 v1, s[24:27], s42 offen sc1 lds
    s_xor_b32 s42, s38, 2
    s_mul_i32 s42, s42, 9216
    s_add_u32 s42, s42, s52
    s_add_u32 s42, s42, 4096
    s_mov_b32 m0, 91136
    s_nop 0
    buffer_load_dwordx4 v1, s[24:27], s42 offen sc1 lds
    s_xor_b32 s42, s38, 3
    s_mul_i32 s42, s42, 9216
    s_add_u32 s42, s42, s52
    s_add_u32 s42, s42, 4096
    s_mov_b32 m0, 81920
    s_nop 0
    buffer_load_dwordx4 v1, s[24:27], s42 offen sc1 lds
L_g4:
    v_and_b32 v33, 15, v0
    v_lshrrev_b32 v34, 4, v0
    v_mov_b32 v35, 0x3f80
    v_and_b32 v36, 1, v0
    v_lshlrev_b32 v36, 4, v36
    v_lshlrev_b32 v35, v36, v35
    v_lshrrev_b32 v36, 1, v33
    v_cmp_eq_u32 vcc, 0, v36
    s_nop 1
    v_cndmask_b32 v40, 0, v35, vcc
    v_cmp_eq_u32 vcc, 1, v36
    s_nop 1
    v_cndmask_b32 v41, 0, v35, vcc
    v_cmp_eq_u32 vcc, 2, v36
    s_nop 1
    v_cndmask_b32 v42, 0, v35, vcc
    v_cmp_eq_u32 vcc, 3, v36
    s_nop 1
    v_cndmask_b32 v43, 0, v35, vcc
    v_cmp_eq_u32 vcc, 4, v36
    s_nop 1
    v_cndmask_b32 v44, 0, v35, vcc
    v_cmp_eq_u32 vcc, 5, v36
    s_nop 1
    v_cndmask_b32 v45, 0, v35, vcc
    v_cmp_eq_u32 vcc, 6, v36
    s_nop 1
    v_cndmask_b32 v46, 0, v35, vcc
    v_cmp_eq_u32 vcc, 7, v36
    s_nop 1
    v_cndmask_b32 v47, 0, v35, vcc
    s_waitcnt vmcnt(0)
    s_barrier
    s_branch L_reduce
.p2align 12
L_helper:
    s_lshl_b32 s54, s37, 7
    s_add_u32 s54, s54, s50
    s_waitcnt vmcnt(1)
    s_cmp_lg_u32 s83, 0
    s_cbranch_scc1 L_nordy
    s_lshl_b32 s42, s39, 3
    s_add_u32 s42, s42, s37
    s_lshl_b32 s42, s42, 2
    s_mov_b64 exec, 1
    buffer_store_dword v61, v56, s[32:35], s42 offen sc1
    s_mov_b64 exec, -1
L_nordy:
    s_barrier
    ds_read2st64_b64 v[160:163], v2 offset0:0 offset1:1
    ds_read_b128 v[204:207], v20 offset:0
    ds_read2st64_b64 v[164:167], v2 offset0:2 offset1:3
    ds_read_b128 v[216:219], v21 offset:0
    ds_read2st64_b64 v[168:171], v2 offset0:4 offset1:5
    ds_read_b128 v[228:231], v22 offset:0
    ds_read2st64_b64 v[172:175], v2 offset0:6 offset1:7
    ds_read_b128 v[240:243], v23 offset:0
    ds_read_b128 v[244:247], v23 offset:4096
    ds_read_b128 v[232:235], v22 offset:4096
    ds_read_b128 v[220:223], v21 offset:4096
    ds_read_b128 v[208:211], v20 offset:4096
    ds_read_b128 v[212:215], v20 offset:8192
    ds_read_b128 v[224:227], v21 offset:8192
    ds_read_b128 v[236:239], v22 offset:8192
    ds_read_b128 v[248:251], v23 offset:8192
    s_barrier
    s_waitcnt lgkmcnt(14)
    v_mfma_f32_16x16x32_bf16 v[176:179], v[204:207], v[160:163], 0
    s_waitcnt lgkmcnt(12)
    v_mfma_f32_16x16x32_bf16 v[176:179], v[216:219], v[164:167], v[176:179]
    s_waitcnt lgkmcnt(10)
    v_mfma_f32_16x16x32_bf16 v[176:179], v[228:231], v[168:171], v[176:179]
    s_waitcnt lgkmcnt(8)
    v_mfma_f32_16x16x32_bf16 v[176:179], v[240:243], v[172:175], v[176:179]
    s_waitcnt lgkmcnt(7)
    v_mfma_f32_16x16x32_bf16 v[180:183], v[244:247], v[172:175], 0
    s_waitcnt lgkmcnt(6)
    v_mfma_f32_16x16x32_bf16 v[180:183], v[232:235], v[168:171], v[180:183]
    s_waitcnt lgkmcnt(5)
    v_mfma_f32_16x16x32_bf16 v[180:183], v[220:223], v[164:167], v[180:183]
    s_waitcnt lgkmcnt(4)
    v_mfma_f32_16x16x32_bf16 v[180:183], v[208:211], v[160:163], v[180:183]
    s_waitcnt lgkmcnt(3)
    v_mfma_f32_16x16x32_bf16 v[184:187], v[212:215], v[160:163], 0
    s_waitcnt lgkmcnt(2)
    v_mfma_f32_16x16x32_bf16 v[184:187], v[224:227], v[164:167], v[184:187]
    s_waitcnt lgkmcnt(1)
    v_mfma_f32_16x16x32_bf16 v[184:187], v[236:239], v[168:171], v[184:187]
    s_waitcnt lgkmcnt(0)
    v_mfma_f32_16x16x32_bf16 v[184:187], v[248:251], v[172:175], v[184:187]
    v_max3_f32 v24, v176, v177, v178
    v_max3_f32 v25, v179, v180, v181
    v_max3_f32 v24, v24, v182, v183
    s_nop 4
    v_max3_f32 v25, v25, v184, v185
    v_max3_f32 v24, v24, v186, v187
    v_max_f32 v24, v24, v25
    v_mov_b32 v25, v24
    s_nop 1
    v_permlane32_swap_b32 v24, v25
    v_max_f32 v24, v24, v25
    v_mov_b32 v25, v24
    s_nop 1
    v_permlane16_swap_b32 v24, v25
    v_max_f32 v24, v24, v25
    v_mul_f32 v24, s101, v24
    v_pk_fma_f32 v[176:177], v[176:177], s[100:101], v[24:25] op_sel_hi:[1,0,0]
    v_pk_fma_f32 v[178:179], v[178:179], s[100:101], v[24:25] op_sel_hi:[1,0,0]
    v_pk_fma_f32 v[180:181], v[180:181], s[100:101], v[24:25] op_sel_hi:[1,0,0]
    v_pk_fma_f32 v[182:183], v[182:183], s[100:101], v[24:25] op_sel_hi:[1,0,0]
    v_pk_fma_f32 v[184:185], v[184:185], s[100:101], v[24:25] op_sel_hi:[1,0,0]
    v_pk_fma_f32 v[186:187], v[186:187], s[100:101], v[24:25] op_sel_hi:[1,0,0]
    v_exp_f32 v176, v176
    v_exp_f32 v177, v177
    v_exp_f32 v178, v178
    v_exp_f32 v179, v179
    v_exp_f32 v180, v180
    v_pk_add_f32 v[26:27], v[176:177], v[178:179]
    v_exp_f32 v181, v181
    v_exp_f32 v182, v182
    v_pk_add_f32 v[26:27], v[26:27], v[180:181]
    v_exp_f32 v183, v183
    v_exp_f32 v184, v184
    v_pk_add_f32 v[26:27], v[26:27], v[182:183]
    v_exp_f32 v185, v185
    v_exp_f32 v186, v186
    v_pk_add_f32 v[26:27], v[26:27], v[184:185]
    v_exp_f32 v187, v187
    s_nop 0
    v_pk_add_f32 v[26:27], v[26:27], v[186:187]
    v_add_f32 v25, v26, v27
    v_mov_b32 v26, v25
    s_nop 1
    v_permlane32_swap_b32 v25, v26
    v_add_f32 v25, v25, v26
    v_mov_b32 v26, v25
    s_nop 1
    v_permlane16_swap_b32 v25, v26
    v_add_f32 v25, v25, v26
    v_rcp_f32 v24, v25
    s_nop 0
    v_pk_mul_f32 v[176:177], v[176:177], v[24:25] op_sel_hi:[1,0]
    v_pk_mul_f32 v[178:179], v[178:179], v[24:25] op_sel_hi:[1,0]
    v_pk_mul_f32 v[180:181], v[180:181], v[24:25] op_sel_hi:[1,0]
    v_pk_mul_f32 v[182:183], v[182:183], v[24:25] op_sel_hi:[1,0]
    v_pk_mul_f32 v[184:185], v[184:185], v[24:25] op_sel_hi:[1,0]
    v_pk_mul_f32 v[186:187], v[186:187], v[24:25] op_sel_hi:[1,0]
    v_cvt_pk_bf16_f32 v188, v176, v177
    v_cvt_pk_bf16_f32 v189, v178, v179
    v_cvt_pk_bf16_f32 v190, v180, v181
    v_cvt_pk_bf16_f32 v191, v182, v183
    v_cvt_pk_bf16_f32 v192, v184, v185
    v_cvt_pk_bf16_f32 v193, v186, v187
    buffer_store_dwordx4 v[188:191], v4, s[24:27], s55 offen sc1
    buffer_store_dwordx2 v[192:193], v5, s[24:27], s55 offen offset:1024 sc1
    ds_write_b128 v4, v[188:191]
    ds_write_b64 v5, v[192:193] offset:1024
    s_waitcnt lgkmcnt(0)
    s_barrier
    v_mov_b32 v28, 1
    s_lshl_b32 s42, s38, 2
    v_mov_b32 v29, s42
    s_barrier
    s_lshl_b32 s45, s39, 5
    s_buffer_load_dwordx8 s[92:99], s[32:35], s45
    s_barrier
    v_and_b32 v33, 15, v0
    v_lshrrev_b32 v34, 4, v0
    v_mov_b32 v35, 0x3f80
    v_and_b32 v36, 1, v0
    v_lshlrev_b32 v36, 4, v36
    v_lshlrev_b32 v35, v36, v35
    v_lshrrev_b32 v36, 1, v33
    v_cmp_eq_u32 vcc, 0, v36
    s_nop 1
    v_cndmask_b32 v40, 0, v35, vcc
    v_cmp_eq_u32 vcc, 1, v36
    s_nop 1
    v_cndmask_b32 v41, 0, v35, vcc
    v_cmp_eq_u32 vcc, 2, v36
    s_nop 1
    v_cndmask_b32 v42, 0, v35, vcc
    v_cmp_eq_u32 vcc, 3, v36
    s_nop 1
    v_cndmask_b32 v43, 0, v35, vcc
    v_cmp_eq_u32 vcc, 4, v36
    s_nop 1
    v_cndmask_b32 v44, 0, v35, vcc
    v_cmp_eq_u32 vcc, 5, v36
    s_nop 1
    v_cndmask_b32 v45, 0, v35, vcc
    v_cmp_eq_u32 vcc, 6, v36
    s_nop 1
    v_cndmask_b32 v46, 0, v35, vcc
    v_cmp_eq_u32 vcc, 7, v36
    s_nop 1
    v_cndmask_b32 v47, 0, v35, vcc
    s_waitcnt lgkmcnt(0)
    s_and_b64 s[92:93], s[92:93], s[94:95]
    s_and_b64 s[96:97], s[96:97], s[98:99]
    s_and_b64 s[92:93], s[92:93], s[96:97]
    s_and_b32 s51, s92, s93
    s_cmp_lg_u32 s51, 0
    s_cbranch_scc1 L_ready
    s_mov_b32 s60, 0
    v_and_b32 v25, 7, v0
    v_lshlrev_b32 v25, 2, v25
L_rdy_poll:
    buffer_load_dword v24, v25, s[32:35], s45 offen sc1
    s_waitcnt vmcnt(0)
    v_cmp_eq_u32 vcc, 0, v24
    s_cbranch_vccz L_ready
    s_add_u32 s60, s60, 1
    s_cmp_lt_u32 s60, 0x40000
    s_cbranch_scc1 L_rdy_poll
L_ready:
    s_waitcnt vmcnt(0)
    s_barrier
    s_mov_b64 exec, 1
    s_cmp_lg_u32 s40, 0
    s_cbranch_scc1 L_pslow
    buffer_store_dword v28, v29, s[24:27], s54 offen
    s_branch L_pset
L_pslow:
    buffer_store_dword v28, v29, s[24:27], s54 offen offset:1024 sc1
L_pset:
    s_mov_b64 exec, -1
    s_barrier
    s_barrier
    s_barrier
L_reduce:
    v_lshrrev_b32 v36, 3, v33
    v_and_b32 v37, 3, v0
    v_lshl_add_u32 v36, v36, 2, v37
    v_mul_u32_u24 v36, 1152, v36
    v_bfe_u32 v37, v0, 2, 1
    v_lshl_add_u32 v36, v37, 5, v36
    v_lshl_add_u32 v48, v34, 3, v36
    v_lshlrev_b32 v36, 4, v33
    s_cmp_eq_u32 s36, 4
    s_cbranch_scc1 L_red_c8
    s_sub_u32 s51, s36, 5
    s_lshr_b32 s52, s37, 1
    s_and_b32 s53, s37, 1
    s_mul_i32 s42, s38, 196608
    s_add_u32 s42, s42, s50
    s_add_u32 s42, s42, 790528
    s_mul_i32 s43, s52, 3
    s_add_u32 s43, s43, s51
    s_lshl_b32 s43, s43, 2
    s_add_u32 s43, s43, s53
    s_lshl_b32 s43, s43, 9
    s_add_u32 s56, s42, s43
    s_add_u32 s57, s56, 98304
    v_add_u32 v27, s43, v36
    v_add_u32 v28, 4, v34
    v_cmp_eq_u32 s[70:71], s37, v34
    v_cmp_eq_u32 s[72:73], s37, v28
    s_lshl_b32 s42, s39, 1
    s_lshr_b32 s43, s52, 1
    s_add_u32 s42, s42, s43
    s_mul_i32 s42, s42, 3
    s_add_u32 s42, s42, s51
    s_lshl_b32 s42, s42, 1
    s_add_u32 s42, s42, s53
    s_mul_i32 s42, s42, 9216
    s_and_b32 s44, s52, 1
    s_lshl_b32 s43, s38, 1
    s_add_u32 s43, s43, s44
    s_lshl_b32 s43, s43, 7
    s_add_u32 s58, s42, s43
    s_lshl_b32 s42, s38, 2
    s_add_u32 s42, s42, s52
    s_lshl_b32 s42, s42, 7
    s_add_u32 s42, s42, s50
    s_add_u32 s54, s42, 2048
    v_mul_u32_u24 v37, 24576, v34
    v_add_u32 v49, v36, v37
    v_lshlrev_b32 v26, 2, v0
    s_barrier
    s_or_b64 exec, s[70:71], s[72:73]
    s_cmp_ge_u32 s37, 4
    s_cbranch_scc1 L_own1
    ds_read_b128 v[64:67], v27 offset:0
    ds_read_b128 v[68:71], v27 offset:256
    ds_read_b128 v[80:83], v27 offset:1024
    ds_read_b128 v[84:87], v27 offset:1280
    s_branch L_own2
L_own1:
    ds_read_b128 v[72:75], v27 offset:0
    ds_read_b128 v[76:79], v27 offset:256
    ds_read_b128 v[88:91], v27 offset:1024
    ds_read_b128 v[92:95], v27 offset:1280
L_own2:
    s_not_b64 s[70:71], s[70:71]
    s_not_b64 s[72:73], s[72:73]
    s_mov_b64 exec, 0xff
    s_bitset0_b32 exec_lo, s37
    s_cmp_lg_u32 s36, 5
    s_cbranch_scc1 L_pm_ok
    s_mov_b32 s60, 0
L_pm:
    buffer_load_dword v24, v26, s[24:27], s54 offen sc1
    s_waitcnt vmcnt(0)
    v_cmp_eq_u32 vcc, 0, v24
    s_cbranch_vccz L_pm_ok
    s_add_u32 s60, s60, 1
    s_cmp_lt_u32 s60, 0x40000
    s_cbranch_scc1 L_pm
L_pm_ok:
    s_mov_b64 exec, -1
    s_waitcnt lgkmcnt(0)
    s_barrier
    s_mov_b64 exec, s[70:71]
    buffer_load_dwordx4 v[64:67], v49, s[24:27], s56 offen offset:0 sc1
    buffer_load_dwordx4 v[68:71], v49, s[24:27], s56 offen offset:256 sc1
    s_mov_b64 exec, s[72:73]
    buffer_load_dwordx4 v[72:75], v49, s[24:27], s57 offen offset:0 sc1
    buffer_load_dwordx4 v[76:79], v49, s[24:27], s57 offen offset:256 sc1
    s_mov_b64 exec, s[70:71]
    buffer_load_dwordx4 v[80:83], v49, s[24:27], s56 offen offset:1024 sc1
    buffer_load_dwordx4 v[84:87], v49, s[24:27], s56 offen offset:1280 sc1
    s_mov_b64 exec, s[72:73]
    buffer_load_dwordx4 v[88:91], v49, s[24:27], s57 offen offset:1024 sc1
    buffer_load_dwordx4 v[92:95], v49, s[24:27], s57 offen offset:1280 sc1
    s_mov_b64 exec, -1
    s_waitcnt vmcnt(7)
    v_mfma_f32_16x16x32_bf16 v[52:55], v[64:67], v[40:43], 0
    s_waitcnt vmcnt(6)
    v_mfma_f32_16x16x32_bf16 v[52:55], v[68:71], v[44:47], v[52:55]
    s_waitcnt vmcnt(5)
    v_mfma_f32_16x16x32_bf16 v[52:55], v[72:75], v[40:43], v[52:55]
    s_waitcnt vmcnt(4)
    v_mfma_f32_16x16x32_bf16 v[52:55], v[76:79], v[44:47], v[52:55]
    s_waitcnt vmcnt(3)
    v_mfma_f32_16x16x32_bf16 v[56:59], v[80:83], v[40:43], 0
    s_waitcnt vmcnt(2)
    v_mfma_f32_16x16x32_bf16 v[56:59], v[84:87], v[44:47], v[56:59]
    s_waitcnt vmcnt(1)
    v_mfma_f32_16x16x32_bf16 v[56:59], v[88:91], v[40:43], v[56:59]
    s_waitcnt vmcnt(0)
    v_mfma_f32_16x16x32_bf16 v[56:59], v[92:95], v[44:47], v[56:59]
    v_cvt_pk_bf16_f32 v60, v52, v53
    v_cvt_pk_bf16_f32 v61, v54, v55
    buffer_store_dwordx2 v[60:61], v48, s[28:31], s58 offen offset:0
    s_nop 4
    v_cvt_pk_bf16_f32 v62, v56, v57
    v_cvt_pk_bf16_f32 v63, v58, v59
    buffer_store_dwordx2 v[62:63], v48, s[28:31], s58 offen offset:64
    s_endpgm
L_red_c8:
    s_cmp_ge_u32 s38, 3
    s_cbranch_scc1 L_red_end
    s_lshl_b32 s42, s38, 3
    s_add_u32 s42, s42, s37
    s_lshl_b32 s44, s42, 9
    s_add_u32 s43, s50, s44
    s_add_u32 s56, s43, 397312
    s_and_b32 s53, s42, 1
    s_lshr_b32 s42, s42, 1
    s_mul_i32 s52, s42, 43
    s_lshr_b32 s52, s52, 7
    s_mul_i32 s51, s52, 3
    s_sub_u32 s51, s42, s51
    s_lshl_b32 s42, s39, 1
    s_lshr_b32 s43, s52, 1
    s_add_u32 s42, s42, s43
    s_mul_i32 s42, s42, 3
    s_add_u32 s42, s42, s51
    s_lshl_b32 s42, s42, 1
    s_add_u32 s42, s42, s53
    s_mul_i32 s42, s42, 9216
    s_and_b32 s44, s52, 1
    s_lshl_b32 s44, s44, 6
    s_add_u32 s42, s42, s44
    s_add_u32 s58, s42, 1024
    s_lshl_b32 s54, s52, 9
    s_add_u32 s54, s54, s50
    s_add_u32 s54, s54, 4096
    v_mul_u32_u24 v37, 12288, v34
    v_add_u32 v50, v36, v37
    v_and_b32 v26, 7, v0
    v_lshlrev_b32 v26, 2, v26
    v_bfe_u32 v27, v0, 3, 2
    v_lshl_add_u32 v26, v27, 7, v26
    s_mov_b32 exec_hi, 0
    s_mov_b32 s60, 0
L_pc:
    buffer_load_dword v24, v26, s[24:27], s54 offen sc1
    s_waitcnt vmcnt(0)
    v_cmp_eq_u32 vcc, 0, v24
    s_cbranch_vccz L_pc_ok
    s_add_u32 s60, s60, 1
    s_cmp_lt_u32 s60, 0x40000
    s_cbranch_scc1 L_pc
L_pc_ok:
    s_mov_b64 exec, -1
    s_barrier
    buffer_load_dwordx4 v[64:67], v50, s[24:27], s56 offen offset:0 sc1
    buffer_load_dwordx4 v[68:71], v50, s[24:27], s56 offen offset:256 sc1
    s_add_u32 s56, s56, 49152
    buffer_load_dwordx4 v[72:75], v50, s[24:27], s56 offen offset:0 sc1
    buffer_load_dwordx4 v[76:79], v50, s[24:27], s56 offen offset:256 sc1
    s_add_u32 s56, s56, 49152
    buffer_load_dwordx4 v[80:83], v50, s[24:27], s56 offen offset:0 sc1
    buffer_load_dwordx4 v[84:87], v50, s[24:27], s56 offen offset:256 sc1
    s_add_u32 s56, s56, 49152
    buffer_load_dwordx4 v[88:91], v50, s[24:27], s56 offen offset:0 sc1
    buffer_load_dwordx4 v[92:95], v50, s[24:27], s56 offen offset:256 sc1
    s_add_u32 s56, s56, 49152
    buffer_load_dwordx4 v[96:99], v50, s[24:27], s56 offen offset:0 sc1
    buffer_load_dwordx4 v[100:103], v50, s[24:27], s56 offen offset:256 sc1
    s_add_u32 s56, s56, 49152
    buffer_load_dwordx4 v[104:107], v50, s[24:27], s56 offen offset:0 sc1
    buffer_load_dwordx4 v[108:111], v50, s[24:27], s56 offen offset:256 sc1
    s_add_u32 s56, s56, 49152
    buffer_load_dwordx4 v[112:115], v50, s[24:27], s56 offen offset:0 sc1
    buffer_load_dwordx4 v[116:119], v50, s[24:27], s56 offen offset:256 sc1
    s_add_u32 s56, s56, 49152
    buffer_load_dwordx4 v[120:123], v50, s[24:27], s56 offen offset:0 sc1
    buffer_load_dwordx4 v[124:127], v50, s[24:27], s56 offen offset:256 sc1
    s_barrier
    s_waitcnt vmcnt(15)
    v_mfma_f32_16x16x32_bf16 v[52:55], v[64:67], v[40:43], 0
    s_waitcnt vmcnt(14)
    v_mfma_f32_16x16x32_bf16 v[52:55], v[68:71], v[44:47], v[52:55]
    s_waitcnt vmcnt(13)
    v_mfma_f32_16x16x32_bf16 v[52:55], v[72:75], v[40:43], v[52:55]
    s_waitcnt vmcnt(12)
    v_mfma_f32_16x16x32_bf16 v[52:55], v[76:79], v[44:47], v[52:55]
    s_waitcnt vmcnt(11)
    v_mfma_f32_16x16x32_bf16 v[52:55], v[80:83], v[40:43], v[52:55]
    s_waitcnt vmcnt(10)
    v_mfma_f32_16x16x32_bf16 v[52:55], v[84:87], v[44:47], v[52:55]
    s_waitcnt vmcnt(9)
    v_mfma_f32_16x16x32_bf16 v[52:55], v[88:91], v[40:43], v[52:55]
    s_waitcnt vmcnt(8)
    v_mfma_f32_16x16x32_bf16 v[52:55], v[92:95], v[44:47], v[52:55]
    s_waitcnt vmcnt(7)
    v_mfma_f32_16x16x32_bf16 v[52:55], v[96:99], v[40:43], v[52:55]
    s_waitcnt vmcnt(6)
    v_mfma_f32_16x16x32_bf16 v[52:55], v[100:103], v[44:47], v[52:55]
    s_waitcnt vmcnt(5)
    v_mfma_f32_16x16x32_bf16 v[52:55], v[104:107], v[40:43], v[52:55]
    s_waitcnt vmcnt(4)
    v_mfma_f32_16x16x32_bf16 v[52:55], v[108:111], v[44:47], v[52:55]
    s_waitcnt vmcnt(3)
    v_mfma_f32_16x16x32_bf16 v[52:55], v[112:115], v[40:43], v[52:55]
    s_waitcnt vmcnt(2)
    v_mfma_f32_16x16x32_bf16 v[52:55], v[116:119], v[44:47], v[52:55]
    s_waitcnt vmcnt(1)
    v_mfma_f32_16x16x32_bf16 v[52:55], v[120:123], v[40:43], v[52:55]
    s_waitcnt vmcnt(0)
    v_mfma_f32_16x16x32_bf16 v[52:55], v[124:127], v[44:47], v[52:55]
    s_nop 7
    v_cvt_pk_bf16_f32 v60, v52, v53
    v_cvt_pk_bf16_f32 v61, v54, v55
    buffer_store_dwordx2 v[60:61], v48, s[28:31], s58 offen
L_red_end:
    s_endpgm
.p2align 7
.fill 105, 4, 0xbf800000
L_compute:
    s_load_dwordx2 s[24:25], s[0:1], 56
    s_mov_b32 s26, 268435456
    s_mov_b32 s27, 0x00020000
    s_mul_i32 s50, s39, 1576960
    s_mul_i32 s48, s41, 3
    s_add_u32 s48, s48, s40
    s_add_u32 s48, s48, 1
    v_lshrrev_b32 v26, 4, v0
    v_and_b32 v27, 15, v0
    v_lshlrev_b32 v1, 4, v0
    s_lshl_b32 s42, s48, 12
    v_lshlrev_b32 v28, 3, v0
    v_add_u32 v2, s42, v28
    s_mul_i32 s42, s48, 1536
    s_add_u32 s42, s42, 101376
    v_add_u32 v4, s42, v1
    v_add_u32 v5, s42, v28
    s_lshl_b32 s55, s37, 2
    s_add_u32 s55, s55, s38
    s_mul_i32 s55, s55, 9216
    s_add_u32 s55, s55, s50
    s_add_u32 s55, s55, 1024
    s_cmp_ge_u32 s48, 3
    s_cselect_b32 s43, 12288, 0
    s_add_u32 s43, s43, 24576
    v_xor_b32 v28, v26, v27
    v_lshlrev_b32 v28, 4, v28
    v_lshl_add_u32 v28, v27, 8, v28
    v_xor_b32 v20, 0, v28
    v_add_u32 v20, s43, v20
    v_xor_b32 v21, 64, v28
    v_add_u32 v21, s43, v21
    v_xor_b32 v22, 128, v28
    v_add_u32 v22, s43, v22
    v_xor_b32 v23, 192, v28
    v_add_u32 v23, s43, v23
    s_mov_b32 s100, 0x3e0293ee
    s_mov_b32 s101, 0xbe0293ee
    v_bfe_u32 v24, v0, 2, 2
    v_bfe_u32 v25, v0, 3, 2
    v_and_b32 v28, 3, v0
    v_lshlrev_b32 v28, 3, v28
    v_lshl_add_u32 v28, v25, 5, v28
    v_lshl_add_u32 v28, v24, 7, v28
    v_lshl_add_u32 v29, v26, 10, v28
    s_lshl_b32 s42, s40, 12
    v_xor_b32 v8, 0, v29
    v_add_u32 v8, s42, v8
    v_add_u32 v12, 90112, v8
    v_xor_b32 v9, 32, v29
    v_add_u32 v9, s42, v9
    v_add_u32 v13, 90112, v9
    v_xor_b32 v10, 64, v29
    v_add_u32 v10, s42, v10
    v_add_u32 v14, 90112, v10
    v_xor_b32 v11, 96, v29
    v_add_u32 v11, s42, v11
    v_add_u32 v15, 90112, v11
    s_lshl_b32 s42, s40, 6
    v_xor_b32 v16, s42, v29
    v_xor_b32 v17, 32, v16
    v_add_u32 v16, 73728, v16
    v_add_u32 v17, 73728, v17
    s_mul_i32 s42, s41, 6144
    s_add_u32 s42, s42, 73728
    v_lshrrev_b32 v28, 1, v27
    v_xor_b32 v28, v28, v26
    v_lshlrev_b32 v28, 4, v28
    v_lshl_add_u32 v28, v27, 7, v28
    v_xor_b32 v29, 64, v28
    v_add_u32 v18, s42, v28
    v_add_u32 v19, s42, v29
    s_mul_i32 s42, s41, 4608
    s_add_u32 s42, s42, 73728
    v_add_u32 v6, s42, v1
    v_lshlrev_b32 v28, 3, v0
    v_add_u32 v7, s42, v28
    s_lshl_b32 s42, s38, 3
    s_add_u32 s42, s42, s37
    s_lshl_b32 s42, s42, 2
    s_add_u32 s42, s42, s36
    s_mul_i32 s51, s42, 6144
    s_add_u32 s51, s51, s50
    s_add_u32 s51, s51, 790528
    s_add_u32 s52, s51, 4096
    s_mul_i32 s53, s42, 3072
    s_add_u32 s53, s53, s50
    s_add_u32 s53, s53, 397312
    s_lshl_b32 s42, s36, 2
    s_add_u32 s42, s42, s38
    s_lshl_b32 s42, s42, 5
    s_add_u32 s42, s42, s37
    s_lshl_b32 s42, s42, 2
    s_add_u32 s47, s42, s50
    s_add_u32 s47, s47, 4096
    s_lshl_b32 s42, s38, 2
    s_add_u32 s42, s42, s36
    s_lshl_b32 s42, s42, 5
    s_add_u32 s42, s42, s37
    s_lshl_b32 s42, s42, 2
    s_add_u32 s54, s42, s50
    s_mul_i32 s42, s41, 12288
    s_lshl_b32 s43, s40, 11
    s_add_u32 s42, s42, s43
    v_lshrrev_b32 v28, 1, v26
    v_lshlrev_b32 v28, 7, v28
    v_lshl_add_u32 v28, v27, 3, v28
    v_and_b32 v29, 1, v26
    v_lshlrev_b32 v29, 9, v29
    v_add3_u32 v3, v28, v29, s42
    s_lshl_b32 s49, s36, 1
    s_mul_i32 s46, s36, 6144
    s_waitcnt lgkmcnt(0)
    s_barrier
    ds_read_b128 v[64:67], v18 offset:0
    ds_read_b128 v[76:79], v19 offset:0
    ds_read_b64_tr_b16 v[32:33], v12 offset:20480
    ds_read_b64_tr_b16 v[34:35], v12 offset:20992
    ds_read_b64_tr_b16 v[36:37], v12 offset:28672
    ds_read_b64_tr_b16 v[38:39], v12 offset:29184
    ds_read_b128 v[68:71], v18 offset:2048
    ds_read_b128 v[80:83], v19 offset:2048
    ds_read_b128 v[72:75], v18 offset:4096
    ds_read_b128 v[84:87], v19 offset:4096
    s_waitcnt lgkmcnt(6)
    v_mfma_f32_16x16x32_bf16 v[112:115], v[32:35], v[64:67], 0
    ds_read_b64_tr_b16 v[40:41], v13 offset:20480
    s_waitcnt lgkmcnt(5)
    v_mfma_f32_16x16x32_bf16 v[112:115], v[36:39], v[76:79], v[112:115]
    ds_read_b64_tr_b16 v[42:43], v13 offset:20992
    s_waitcnt lgkmcnt(5)
    v_mfma_f32_16x16x32_bf16 v[116:119], v[32:35], v[68:71], 0
    ds_read_b64_tr_b16 v[44:45], v13 offset:28672
    s_waitcnt lgkmcnt(5)
    v_mfma_f32_16x16x32_bf16 v[116:119], v[36:39], v[80:83], v[116:119]
    ds_read_b64_tr_b16 v[46:47], v13 offset:29184
    s_waitcnt lgkmcnt(5)
    v_mfma_f32_16x16x32_bf16 v[120:123], v[32:35], v[72:75], 0
    ds_read_b64_tr_b16 v[48:49], v14 offset:20480
    s_waitcnt lgkmcnt(5)
    v_mfma_f32_16x16x32_bf16 v[120:123], v[36:39], v[84:87], v[120:123]
    ds_read_b64_tr_b16 v[50:51], v14 offset:20992
    s_waitcnt lgkmcnt(4)
    v_mfma_f32_16x16x32_bf16 v[132:135], v[40:43], v[72:75], 0
    ds_read_b64_tr_b16 v[52:53], v14 offset:28672
    s_waitcnt lgkmcnt(3)
    v_mfma_f32_16x16x32_bf16 v[132:135], v[44:47], v[84:87], v[132:135]
    ds_read_b64_tr_b16 v[54:55], v14 offset:29184
    v_mfma_f32_16x16x32_bf16 v[128:131], v[40:43], v[68:71], 0
    ds_read_b64_tr_b16 v[56:57], v15 offset:20480
    v_mfma_f32_16x16x32_bf16 v[128:131], v[44:47], v[80:83], v[128:131]
    ds_read_b64_tr_b16 v[58:59], v15 offset:20992
    v_mfma_f32_16x16x32_bf16 v[124:127], v[40:43], v[64:67], 0
    ds_read_b64_tr_b16 v[60:61], v15 offset:28672
    v_mfma_f32_16x16x32_bf16 v[124:127], v[44:47], v[76:79], v[124:127]
    ds_read_b64_tr_b16 v[62:63], v15 offset:29184
    s_waitcnt lgkmcnt(6)
    v_mfma_f32_16x16x32_bf16 v[136:139], v[48:51], v[64:67], 0
    s_waitcnt lgkmcnt(4)
    v_mfma_f32_16x16x32_bf16 v[136:139], v[52:55], v[76:79], v[136:139]
    v_mfma_f32_16x16x32_bf16 v[140:143], v[48:51], v[68:71], 0
    s_waitcnt lgkmcnt(0)
    s_barrier
    v_mfma_f32_16x16x32_bf16 v[140:143], v[52:55], v[80:83], v[140:143]
    ds_read_b128 v[88:91], v18 offset:12288
    ds_read_b128 v[100:103], v19 offset:12288
    v_mfma_f32_16x16x32_bf16 v[144:147], v[48:51], v[72:75], 0
    ds_read_b64_tr_b16 v[32:33], v12 offset:36864
    v_mfma_f32_16x16x32_bf16 v[144:147], v[52:55], v[84:87], v[144:147]
    ds_read_b64_tr_b16 v[34:35], v12 offset:37376
    v_mfma_f32_16x16x32_bf16 v[156:159], v[56:59], v[72:75], 0
    ds_read_b64_tr_b16 v[36:37], v12 offset:45056
    v_mfma_f32_16x16x32_bf16 v[156:159], v[60:63], v[84:87], v[156:159]
    ds_read_b64_tr_b16 v[38:39], v12 offset:45568
    v_mfma_f32_16x16x32_bf16 v[152:155], v[56:59], v[68:71], 0
    ds_read_b128 v[92:95], v18 offset:14336
    v_mfma_f32_16x16x32_bf16 v[152:155], v[60:63], v[80:83], v[152:155]
    ds_read_b128 v[104:107], v19 offset:14336
    v_mfma_f32_16x16x32_bf16 v[148:151], v[56:59], v[64:67], 0
    ds_read_b128 v[96:99], v18 offset:16384
    v_mfma_f32_16x16x32_bf16 v[148:151], v[60:63], v[76:79], v[148:151]
    ds_read_b128 v[108:111], v19 offset:16384
    s_waitcnt lgkmcnt(6)
    v_mfma_f32_16x16x32_bf16 v[112:115], v[32:35], v[88:91], v[112:115]
    ds_read_b64_tr_b16 v[40:41], v13 offset:36864
    s_waitcnt lgkmcnt(5)
    v_mfma_f32_16x16x32_bf16 v[112:115], v[36:39], v[100:103], v[112:115]
    ds_read_b64_tr_b16 v[42:43], v13 offset:37376
    s_waitcnt lgkmcnt(5)
    v_mfma_f32_16x16x32_bf16 v[116:119], v[32:35], v[92:95], v[116:119]
    ds_read_b64_tr_b16 v[44:45], v13 offset:45056
    s_waitcnt lgkmcnt(5)
    v_mfma_f32_16x16x32_bf16 v[116:119], v[36:39], v[104:107], v[116:119]
    ds_read_b64_tr_b16 v[46:47], v13 offset:45568
    s_waitcnt lgkmcnt(5)
    v_mfma_f32_16x16x32_bf16 v[120:123], v[32:35], v[96:99], v[120:123]
    ds_read_b64_tr_b16 v[48:49], v14 offset:36864
    s_waitcnt lgkmcnt(5)
    v_mfma_f32_16x16x32_bf16 v[120:123], v[36:39], v[108:111], v[120:123]
    ds_read_b64_tr_b16 v[50:51], v14 offset:37376
    s_waitcnt lgkmcnt(4)
    v_mfma_f32_16x16x32_bf16 v[132:135], v[40:43], v[96:99], v[132:135]
    ds_read_b64_tr_b16 v[52:53], v14 offset:45056
    s_waitcnt lgkmcnt(3)
    v_mfma_f32_16x16x32_bf16 v[132:135], v[44:47], v[108:111], v[132:135]
    ds_read_b64_tr_b16 v[54:55], v14 offset:45568
    v_mfma_f32_16x16x32_bf16 v[128:131], v[40:43], v[92:95], v[128:131]
    ds_read_b64_tr_b16 v[56:57], v15 offset:36864
    v_mfma_f32_16x16x32_bf16 v[128:131], v[44:47], v[104:107], v[128:131]
    ds_read_b64_tr_b16 v[58:59], v15 offset:37376
    v_mfma_f32_16x16x32_bf16 v[124:127], v[40:43], v[88:91], v[124:127]
    ds_read_b64_tr_b16 v[60:61], v15 offset:45056
    v_mfma_f32_16x16x32_bf16 v[124:127], v[44:47], v[100:103], v[124:127]
    ds_read_b64_tr_b16 v[62:63], v15 offset:45568
    s_waitcnt lgkmcnt(6)
    v_mfma_f32_16x16x32_bf16 v[136:139], v[48:51], v[88:91], v[136:139]
    s_waitcnt lgkmcnt(4)
    v_mfma_f32_16x16x32_bf16 v[136:139], v[52:55], v[100:103], v[136:139]
    v_mfma_f32_16x16x32_bf16 v[140:143], v[48:51], v[92:95], v[140:143]
    s_waitcnt lgkmcnt(0)
    s_barrier
    v_mfma_f32_16x16x32_bf16 v[140:143], v[52:55], v[104:107], v[140:143]
    ds_read_b128 v[64:67], v18 offset:24576
    ds_read_b128 v[76:79], v19 offset:24576
    v_mfma_f32_16x16x32_bf16 v[144:147], v[48:51], v[96:99], v[144:147]
    ds_read_b64_tr_b16 v[32:33], v12 offset:53248
    v_mfma_f32_16x16x32_bf16 v[144:147], v[52:55], v[108:111], v[144:147]
    ds_read_b64_tr_b16 v[34:35], v12 offset:53760
    v_mfma_f32_16x16x32_bf16 v[156:159], v[56:59], v[96:99], v[156:159]
    ds_read_b64_tr_b16 v[36:37], v12 offset:61440
    v_mfma_f32_16x16x32_bf16 v[156:159], v[60:63], v[108:111], v[156:159]
    ds_read_b64_tr_b16 v[38:39], v12 offset:61952
    v_mfma_f32_16x16x32_bf16 v[152:155], v[56:59], v[92:95], v[152:155]
    ds_read_b128 v[68:71], v18 offset:26624
    v_mfma_f32_16x16x32_bf16 v[152:155], v[60:63], v[104:107], v[152:155]
    ds_read_b128 v[80:83], v19 offset:26624
    v_mfma_f32_16x16x32_bf16 v[148:151], v[56:59], v[88:91], v[148:151]
    ds_read_b128 v[72:75], v18 offset:28672
    v_mfma_f32_16x16x32_bf16 v[148:151], v[60:63], v[100:103], v[148:151]
    ds_read_b128 v[84:87], v19 offset:28672
    s_waitcnt lgkmcnt(6)
    v_mfma_f32_16x16x32_bf16 v[112:115], v[32:35], v[64:67], v[112:115]
    ds_read_b64_tr_b16 v[40:41], v13 offset:53248
    s_waitcnt lgkmcnt(5)
    v_mfma_f32_16x16x32_bf16 v[112:115], v[36:39], v[76:79], v[112:115]
    ds_read_b64_tr_b16 v[42:43], v13 offset:53760
    s_waitcnt lgkmcnt(5)
    v_mfma_f32_16x16x32_bf16 v[116:119], v[32:35], v[68:71], v[116:119]
    ds_read_b64_tr_b16 v[44:45], v13 offset:61440
    s_waitcnt lgkmcnt(5)
    v_mfma_f32_16x16x32_bf16 v[116:119], v[36:39], v[80:83], v[116:119]
    ds_read_b64_tr_b16 v[46:47], v13 offset:61952
    s_waitcnt lgkmcnt(5)
    v_mfma_f32_16x16x32_bf16 v[120:123], v[32:35], v[72:75], v[120:123]
    ds_read_b64_tr_b16 v[48:49], v14 offset:53248
    s_waitcnt lgkmcnt(5)
    v_mfma_f32_16x16x32_bf16 v[120:123], v[36:39], v[84:87], v[120:123]
    ds_read_b64_tr_b16 v[50:51], v14 offset:53760
    s_waitcnt lgkmcnt(4)
    v_mfma_f32_16x16x32_bf16 v[132:135], v[40:43], v[72:75], v[132:135]
    ds_read_b64_tr_b16 v[52:53], v14 offset:61440
    s_waitcnt lgkmcnt(3)
    v_mfma_f32_16x16x32_bf16 v[132:135], v[44:47], v[84:87], v[132:135]
    ds_read_b64_tr_b16 v[54:55], v14 offset:61952
    v_mfma_f32_16x16x32_bf16 v[128:131], v[40:43], v[68:71], v[128:131]
    ds_read_b64_tr_b16 v[56:57], v15 offset:53248
    v_mfma_f32_16x16x32_bf16 v[128:131], v[44:47], v[80:83], v[128:131]
    ds_read_b64_tr_b16 v[58:59], v15 offset:53760
    v_mfma_f32_16x16x32_bf16 v[124:127], v[40:43], v[64:67], v[124:127]
    ds_read_b64_tr_b16 v[60:61], v15 offset:61440
    v_mfma_f32_16x16x32_bf16 v[124:127], v[44:47], v[76:79], v[124:127]
    ds_read_b64_tr_b16 v[62:63], v15 offset:61952
    s_waitcnt lgkmcnt(6)
    v_mfma_f32_16x16x32_bf16 v[136:139], v[48:51], v[64:67], v[136:139]
    s_waitcnt lgkmcnt(4)
    v_mfma_f32_16x16x32_bf16 v[136:139], v[52:55], v[76:79], v[136:139]
    v_mfma_f32_16x16x32_bf16 v[140:143], v[48:51], v[68:71], v[140:143]
    s_waitcnt lgkmcnt(0)
    s_barrier
    v_mfma_f32_16x16x32_bf16 v[140:143], v[52:55], v[80:83], v[140:143]
    ds_read_b128 v[88:91], v18 offset:0
    ds_read_b128 v[100:103], v19 offset:0
    v_mfma_f32_16x16x32_bf16 v[144:147], v[48:51], v[72:75], v[144:147]
    ds_read_b64_tr_b16 v[32:33], v12 offset:20480
    v_mfma_f32_16x16x32_bf16 v[144:147], v[52:55], v[84:87], v[144:147]
    ds_read_b64_tr_b16 v[34:35], v12 offset:20992
    v_mfma_f32_16x16x32_bf16 v[156:159], v[56:59], v[72:75], v[156:159]
    ds_read_b64_tr_b16 v[36:37], v12 offset:28672
    v_mfma_f32_16x16x32_bf16 v[156:159], v[60:63], v[84:87], v[156:159]
    ds_read_b64_tr_b16 v[38:39], v12 offset:29184
    v_mfma_f32_16x16x32_bf16 v[152:155], v[56:59], v[68:71], v[152:155]
    ds_read_b128 v[92:95], v18 offset:2048
    v_mfma_f32_16x16x32_bf16 v[152:155], v[60:63], v[80:83], v[152:155]
    ds_read_b128 v[104:107], v19 offset:2048
    v_mfma_f32_16x16x32_bf16 v[148:151], v[56:59], v[64:67], v[148:151]
    ds_read_b128 v[96:99], v18 offset:4096
    v_mfma_f32_16x16x32_bf16 v[148:151], v[60:63], v[76:79], v[148:151]
    ds_read_b128 v[108:111], v19 offset:4096
    s_waitcnt lgkmcnt(6)
    v_mfma_f32_16x16x32_bf16 v[112:115], v[32:35], v[88:91], v[112:115]
    ds_read_b64_tr_b16 v[40:41], v13 offset:20480
    s_waitcnt lgkmcnt(5)
    v_mfma_f32_16x16x32_bf16 v[112:115], v[36:39], v[100:103], v[112:115]
    ds_read_b64_tr_b16 v[42:43], v13 offset:20992
    s_waitcnt lgkmcnt(5)
    v_mfma_f32_16x16x32_bf16 v[116:119], v[32:35], v[92:95], v[116:119]
    ds_read_b64_tr_b16 v[44:45], v13 offset:28672
    s_waitcnt lgkmcnt(5)
    v_mfma_f32_16x16x32_bf16 v[116:119], v[36:39], v[104:107], v[116:119]
    ds_read_b64_tr_b16 v[46:47], v13 offset:29184
    s_waitcnt lgkmcnt(5)
    v_mfma_f32_16x16x32_bf16 v[120:123], v[32:35], v[96:99], v[120:123]
    ds_read_b64_tr_b16 v[48:49], v14 offset:20480
    s_waitcnt lgkmcnt(5)
    v_mfma_f32_16x16x32_bf16 v[120:123], v[36:39], v[108:111], v[120:123]
    ds_read_b64_tr_b16 v[50:51], v14 offset:20992
    s_waitcnt lgkmcnt(4)
    v_mfma_f32_16x16x32_bf16 v[132:135], v[40:43], v[96:99], v[132:135]
    ds_read_b64_tr_b16 v[52:53], v14 offset:28672
    s_waitcnt lgkmcnt(3)
    v_mfma_f32_16x16x32_bf16 v[132:135], v[44:47], v[108:111], v[132:135]
    ds_read_b64_tr_b16 v[54:55], v14 offset:29184
    v_mfma_f32_16x16x32_bf16 v[128:131], v[40:43], v[92:95], v[128:131]
    ds_read_b64_tr_b16 v[56:57], v15 offset:20480
    v_mfma_f32_16x16x32_bf16 v[128:131], v[44:47], v[104:107], v[128:131]
    ds_read_b64_tr_b16 v[58:59], v15 offset:20992
    v_mfma_f32_16x16x32_bf16 v[124:127], v[40:43], v[88:91], v[124:127]
    ds_read_b64_tr_b16 v[60:61], v15 offset:28672
    v_mfma_f32_16x16x32_bf16 v[124:127], v[44:47], v[100:103], v[124:127]
    ds_read_b64_tr_b16 v[62:63], v15 offset:29184
    s_waitcnt lgkmcnt(6)
    v_mfma_f32_16x16x32_bf16 v[136:139], v[48:51], v[88:91], v[136:139]
    s_waitcnt lgkmcnt(4)
    v_mfma_f32_16x16x32_bf16 v[136:139], v[52:55], v[100:103], v[136:139]
    v_mfma_f32_16x16x32_bf16 v[140:143], v[48:51], v[92:95], v[140:143]
    s_waitcnt lgkmcnt(0)
    s_barrier
    v_mfma_f32_16x16x32_bf16 v[140:143], v[52:55], v[104:107], v[140:143]
    ds_read_b128 v[64:67], v18 offset:12288
    ds_read_b128 v[76:79], v19 offset:12288
    v_mfma_f32_16x16x32_bf16 v[144:147], v[48:51], v[96:99], v[144:147]
    ds_read_b64_tr_b16 v[32:33], v12 offset:36864
    v_mfma_f32_16x16x32_bf16 v[144:147], v[52:55], v[108:111], v[144:147]
    ds_read_b64_tr_b16 v[34:35], v12 offset:37376
    v_mfma_f32_16x16x32_bf16 v[156:159], v[56:59], v[96:99], v[156:159]
    ds_read_b64_tr_b16 v[36:37], v12 offset:45056
    v_mfma_f32_16x16x32_bf16 v[156:159], v[60:63], v[108:111], v[156:159]
    ds_read_b64_tr_b16 v[38:39], v12 offset:45568
    v_mfma_f32_16x16x32_bf16 v[152:155], v[56:59], v[92:95], v[152:155]
    ds_read_b128 v[68:71], v18 offset:14336
    v_mfma_f32_16x16x32_bf16 v[152:155], v[60:63], v[104:107], v[152:155]
    ds_read_b128 v[80:83], v19 offset:14336
    v_mfma_f32_16x16x32_bf16 v[148:151], v[56:59], v[88:91], v[148:151]
    ds_read_b128 v[72:75], v18 offset:16384
    v_mfma_f32_16x16x32_bf16 v[148:151], v[60:63], v[100:103], v[148:151]
    ds_read_b128 v[84:87], v19 offset:16384
    s_waitcnt lgkmcnt(6)
    v_mfma_f32_16x16x32_bf16 v[112:115], v[32:35], v[64:67], v[112:115]
    ds_read_b64_tr_b16 v[40:41], v13 offset:36864
    s_waitcnt lgkmcnt(5)
    v_mfma_f32_16x16x32_bf16 v[112:115], v[36:39], v[76:79], v[112:115]
    ds_read_b64_tr_b16 v[42:43], v13 offset:37376
    s_waitcnt lgkmcnt(5)
    v_mfma_f32_16x16x32_bf16 v[116:119], v[32:35], v[68:71], v[116:119]
    ds_read_b64_tr_b16 v[44:45], v13 offset:45056
    s_waitcnt lgkmcnt(5)
    v_mfma_f32_16x16x32_bf16 v[116:119], v[36:39], v[80:83], v[116:119]
    ds_read_b64_tr_b16 v[46:47], v13 offset:45568
    s_waitcnt lgkmcnt(5)
    v_mfma_f32_16x16x32_bf16 v[120:123], v[32:35], v[72:75], v[120:123]
    ds_read_b64_tr_b16 v[48:49], v14 offset:36864
    s_waitcnt lgkmcnt(5)
    v_mfma_f32_16x16x32_bf16 v[120:123], v[36:39], v[84:87], v[120:123]
    ds_read_b64_tr_b16 v[50:51], v14 offset:37376
    s_waitcnt lgkmcnt(4)
    v_mfma_f32_16x16x32_bf16 v[132:135], v[40:43], v[72:75], v[132:135]
    ds_read_b64_tr_b16 v[52:53], v14 offset:45056
    s_waitcnt lgkmcnt(3)
    v_mfma_f32_16x16x32_bf16 v[132:135], v[44:47], v[84:87], v[132:135]
    ds_read_b64_tr_b16 v[54:55], v14 offset:45568
    v_mfma_f32_16x16x32_bf16 v[128:131], v[40:43], v[68:71], v[128:131]
    ds_read_b64_tr_b16 v[56:57], v15 offset:36864
    v_mfma_f32_16x16x32_bf16 v[128:131], v[44:47], v[80:83], v[128:131]
    ds_read_b64_tr_b16 v[58:59], v15 offset:37376
    v_mfma_f32_16x16x32_bf16 v[124:127], v[40:43], v[64:67], v[124:127]
    ds_read_b64_tr_b16 v[60:61], v15 offset:45056
    v_mfma_f32_16x16x32_bf16 v[124:127], v[44:47], v[76:79], v[124:127]
    ds_read_b64_tr_b16 v[62:63], v15 offset:45568
    s_waitcnt lgkmcnt(6)
    v_mfma_f32_16x16x32_bf16 v[136:139], v[48:51], v[64:67], v[136:139]
    s_waitcnt lgkmcnt(4)
    v_mfma_f32_16x16x32_bf16 v[136:139], v[52:55], v[76:79], v[136:139]
    v_mfma_f32_16x16x32_bf16 v[140:143], v[48:51], v[68:71], v[140:143]
    s_waitcnt lgkmcnt(0)
    s_barrier
    v_mfma_f32_16x16x32_bf16 v[140:143], v[52:55], v[80:83], v[140:143]
    ds_read_b128 v[88:91], v18 offset:24576
    ds_read_b128 v[100:103], v19 offset:24576
    v_mfma_f32_16x16x32_bf16 v[144:147], v[48:51], v[72:75], v[144:147]
    ds_read_b64_tr_b16 v[32:33], v12 offset:53248
    v_mfma_f32_16x16x32_bf16 v[144:147], v[52:55], v[84:87], v[144:147]
    ds_read_b64_tr_b16 v[34:35], v12 offset:53760
    v_mfma_f32_16x16x32_bf16 v[156:159], v[56:59], v[72:75], v[156:159]
    ds_read_b64_tr_b16 v[36:37], v12 offset:61440
    v_mfma_f32_16x16x32_bf16 v[156:159], v[60:63], v[84:87], v[156:159]
    ds_read_b64_tr_b16 v[38:39], v12 offset:61952
    v_mfma_f32_16x16x32_bf16 v[152:155], v[56:59], v[68:71], v[152:155]
    ds_read_b128 v[92:95], v18 offset:26624
    v_mfma_f32_16x16x32_bf16 v[152:155], v[60:63], v[80:83], v[152:155]
    ds_read_b128 v[104:107], v19 offset:26624
    v_mfma_f32_16x16x32_bf16 v[148:151], v[56:59], v[64:67], v[148:151]
    ds_read_b128 v[96:99], v18 offset:28672
    v_mfma_f32_16x16x32_bf16 v[148:151], v[60:63], v[76:79], v[148:151]
    ds_read_b128 v[108:111], v19 offset:28672
    s_waitcnt lgkmcnt(6)
    v_mfma_f32_16x16x32_bf16 v[112:115], v[32:35], v[88:91], v[112:115]
    ds_read_b64_tr_b16 v[40:41], v13 offset:53248
    s_waitcnt lgkmcnt(5)
    v_mfma_f32_16x16x32_bf16 v[112:115], v[36:39], v[100:103], v[112:115]
    ds_read_b64_tr_b16 v[42:43], v13 offset:53760
    s_waitcnt lgkmcnt(5)
    v_mfma_f32_16x16x32_bf16 v[116:119], v[32:35], v[92:95], v[116:119]
    ds_read_b64_tr_b16 v[44:45], v13 offset:61440
    s_waitcnt lgkmcnt(5)
    v_mfma_f32_16x16x32_bf16 v[116:119], v[36:39], v[104:107], v[116:119]
    ds_read_b64_tr_b16 v[46:47], v13 offset:61952
    s_waitcnt lgkmcnt(5)
    v_mfma_f32_16x16x32_bf16 v[120:123], v[32:35], v[96:99], v[120:123]
    ds_read_b64_tr_b16 v[48:49], v14 offset:53248
    s_waitcnt lgkmcnt(5)
    v_mfma_f32_16x16x32_bf16 v[120:123], v[36:39], v[108:111], v[120:123]
    ds_read_b64_tr_b16 v[50:51], v14 offset:53760
    s_waitcnt lgkmcnt(4)
    v_mfma_f32_16x16x32_bf16 v[132:135], v[40:43], v[96:99], v[132:135]
    ds_read_b64_tr_b16 v[52:53], v14 offset:61440
    s_waitcnt lgkmcnt(3)
    v_mfma_f32_16x16x32_bf16 v[132:135], v[44:47], v[108:111], v[132:135]
    ds_read_b64_tr_b16 v[54:55], v14 offset:61952
    v_mfma_f32_16x16x32_bf16 v[128:131], v[40:43], v[92:95], v[128:131]
    ds_read_b64_tr_b16 v[56:57], v15 offset:53248
    v_mfma_f32_16x16x32_bf16 v[128:131], v[44:47], v[104:107], v[128:131]
    ds_read_b64_tr_b16 v[58:59], v15 offset:53760
    v_mfma_f32_16x16x32_bf16 v[124:127], v[40:43], v[88:91], v[124:127]
    ds_read_b64_tr_b16 v[60:61], v15 offset:61440
    v_mfma_f32_16x16x32_bf16 v[124:127], v[44:47], v[100:103], v[124:127]
    ds_read_b64_tr_b16 v[62:63], v15 offset:61952
    s_waitcnt lgkmcnt(6)
    v_mfma_f32_16x16x32_bf16 v[136:139], v[48:51], v[88:91], v[136:139]
    s_waitcnt lgkmcnt(4)
    v_mfma_f32_16x16x32_bf16 v[136:139], v[52:55], v[100:103], v[136:139]
    v_mfma_f32_16x16x32_bf16 v[140:143], v[48:51], v[92:95], v[140:143]
    s_waitcnt lgkmcnt(0)
    s_barrier
    v_mfma_f32_16x16x32_bf16 v[140:143], v[52:55], v[104:107], v[140:143]
    ds_read_b128 v[64:67], v18 offset:0
    ds_read_b128 v[76:79], v19 offset:0
    v_mfma_f32_16x16x32_bf16 v[144:147], v[48:51], v[96:99], v[144:147]
    ds_read_b64_tr_b16 v[32:33], v12 offset:20480
    v_mfma_f32_16x16x32_bf16 v[144:147], v[52:55], v[108:111], v[144:147]
    ds_read_b64_tr_b16 v[34:35], v12 offset:20992
    v_mfma_f32_16x16x32_bf16 v[156:159], v[56:59], v[96:99], v[156:159]
    ds_read_b64_tr_b16 v[36:37], v12 offset:28672
    v_mfma_f32_16x16x32_bf16 v[156:159], v[60:63], v[108:111], v[156:159]
    ds_read_b64_tr_b16 v[38:39], v12 offset:29184
    v_mfma_f32_16x16x32_bf16 v[152:155], v[56:59], v[92:95], v[152:155]
    ds_read_b128 v[68:71], v18 offset:2048
    v_mfma_f32_16x16x32_bf16 v[152:155], v[60:63], v[104:107], v[152:155]
    ds_read_b128 v[80:83], v19 offset:2048
    v_mfma_f32_16x16x32_bf16 v[148:151], v[56:59], v[88:91], v[148:151]
    ds_read_b128 v[72:75], v18 offset:4096
    v_mfma_f32_16x16x32_bf16 v[148:151], v[60:63], v[100:103], v[148:151]
    ds_read_b128 v[84:87], v19 offset:4096
    s_waitcnt lgkmcnt(6)
    v_mfma_f32_16x16x32_bf16 v[112:115], v[32:35], v[64:67], v[112:115]
    ds_read_b64_tr_b16 v[40:41], v13 offset:20480
    s_waitcnt lgkmcnt(5)
    v_mfma_f32_16x16x32_bf16 v[112:115], v[36:39], v[76:79], v[112:115]
    ds_read_b64_tr_b16 v[42:43], v13 offset:20992
    s_waitcnt lgkmcnt(5)
    v_mfma_f32_16x16x32_bf16 v[116:119], v[32:35], v[68:71], v[116:119]
    ds_read_b64_tr_b16 v[44:45], v13 offset:28672
    s_waitcnt lgkmcnt(5)
    v_mfma_f32_16x16x32_bf16 v[116:119], v[36:39], v[80:83], v[116:119]
    ds_read_b64_tr_b16 v[46:47], v13 offset:29184
    s_waitcnt lgkmcnt(5)
    v_mfma_f32_16x16x32_bf16 v[120:123], v[32:35], v[72:75], v[120:123]
    ds_read_b64_tr_b16 v[48:49], v14 offset:20480
    s_waitcnt lgkmcnt(5)
    v_mfma_f32_16x16x32_bf16 v[120:123], v[36:39], v[84:87], v[120:123]
    ds_read_b64_tr_b16 v[50:51], v14 offset:20992
    s_waitcnt lgkmcnt(4)
    v_mfma_f32_16x16x32_bf16 v[132:135], v[40:43], v[72:75], v[132:135]
    ds_read_b64_tr_b16 v[52:53], v14 offset:28672
    s_waitcnt lgkmcnt(3)
    v_mfma_f32_16x16x32_bf16 v[132:135], v[44:47], v[84:87], v[132:135]
    ds_read_b64_tr_b16 v[54:55], v14 offset:29184
    v_mfma_f32_16x16x32_bf16 v[128:131], v[40:43], v[68:71], v[128:131]
    ds_read_b64_tr_b16 v[56:57], v15 offset:20480
    v_mfma_f32_16x16x32_bf16 v[128:131], v[44:47], v[80:83], v[128:131]
    ds_read_b64_tr_b16 v[58:59], v15 offset:20992
    v_mfma_f32_16x16x32_bf16 v[124:127], v[40:43], v[64:67], v[124:127]
    ds_read_b64_tr_b16 v[60:61], v15 offset:28672
    v_mfma_f32_16x16x32_bf16 v[124:127], v[44:47], v[76:79], v[124:127]
    ds_read_b64_tr_b16 v[62:63], v15 offset:29184
    s_waitcnt lgkmcnt(6)
    v_mfma_f32_16x16x32_bf16 v[136:139], v[48:51], v[64:67], v[136:139]
    s_waitcnt lgkmcnt(4)
    v_mfma_f32_16x16x32_bf16 v[136:139], v[52:55], v[76:79], v[136:139]
    v_mfma_f32_16x16x32_bf16 v[140:143], v[48:51], v[68:71], v[140:143]
    s_waitcnt lgkmcnt(0)
    s_barrier
    v_mfma_f32_16x16x32_bf16 v[140:143], v[52:55], v[80:83], v[140:143]
    ds_read_b128 v[88:91], v18 offset:12288
    ds_read_b128 v[100:103], v19 offset:12288
    v_mfma_f32_16x16x32_bf16 v[144:147], v[48:51], v[72:75], v[144:147]
    ds_read_b64_tr_b16 v[32:33], v12 offset:36864
    v_mfma_f32_16x16x32_bf16 v[144:147], v[52:55], v[84:87], v[144:147]
    ds_read_b64_tr_b16 v[34:35], v12 offset:37376
    v_mfma_f32_16x16x32_bf16 v[156:159], v[56:59], v[72:75], v[156:159]
    ds_read_b64_tr_b16 v[36:37], v12 offset:45056
    v_mfma_f32_16x16x32_bf16 v[156:159], v[60:63], v[84:87], v[156:159]
    ds_read_b64_tr_b16 v[38:39], v12 offset:45568
    v_mfma_f32_16x16x32_bf16 v[152:155], v[56:59], v[68:71], v[152:155]
    ds_read_b128 v[92:95], v18 offset:14336
    v_mfma_f32_16x16x32_bf16 v[152:155], v[60:63], v[80:83], v[152:155]
    ds_read_b128 v[104:107], v19 offset:14336
    v_mfma_f32_16x16x32_bf16 v[148:151], v[56:59], v[64:67], v[148:151]
    ds_read_b128 v[96:99], v18 offset:16384
    v_mfma_f32_16x16x32_bf16 v[148:151], v[60:63], v[76:79], v[148:151]
    ds_read_b128 v[108:111], v19 offset:16384
    s_waitcnt lgkmcnt(6)
    v_mfma_f32_16x16x32_bf16 v[112:115], v[32:35], v[88:91], v[112:115]
    ds_read_b64_tr_b16 v[40:41], v13 offset:36864
    s_waitcnt lgkmcnt(5)
    v_mfma_f32_16x16x32_bf16 v[112:115], v[36:39], v[100:103], v[112:115]
    ds_read_b64_tr_b16 v[42:43], v13 offset:37376
    s_waitcnt lgkmcnt(5)
    v_mfma_f32_16x16x32_bf16 v[116:119], v[32:35], v[92:95], v[116:119]
    ds_read_b64_tr_b16 v[44:45], v13 offset:45056
    s_waitcnt lgkmcnt(5)
    v_mfma_f32_16x16x32_bf16 v[116:119], v[36:39], v[104:107], v[116:119]
    ds_read_b64_tr_b16 v[46:47], v13 offset:45568
    s_waitcnt lgkmcnt(5)
    v_mfma_f32_16x16x32_bf16 v[120:123], v[32:35], v[96:99], v[120:123]
    ds_read_b64_tr_b16 v[48:49], v14 offset:36864
    s_waitcnt lgkmcnt(5)
    v_mfma_f32_16x16x32_bf16 v[120:123], v[36:39], v[108:111], v[120:123]
    ds_read_b64_tr_b16 v[50:51], v14 offset:37376
    s_waitcnt lgkmcnt(4)
    v_mfma_f32_16x16x32_bf16 v[132:135], v[40:43], v[96:99], v[132:135]
    ds_read_b64_tr_b16 v[52:53], v14 offset:45056
    s_waitcnt lgkmcnt(3)
    v_mfma_f32_16x16x32_bf16 v[132:135], v[44:47], v[108:111], v[132:135]
    ds_read_b64_tr_b16 v[54:55], v14 offset:45568
    v_mfma_f32_16x16x32_bf16 v[128:131], v[40:43], v[92:95], v[128:131]
    ds_read_b64_tr_b16 v[56:57], v15 offset:36864
    v_mfma_f32_16x16x32_bf16 v[128:131], v[44:47], v[104:107], v[128:131]
    ds_read_b64_tr_b16 v[58:59], v15 offset:37376
    v_mfma_f32_16x16x32_bf16 v[124:127], v[40:43], v[88:91], v[124:127]
    ds_read_b64_tr_b16 v[60:61], v15 offset:45056
    v_mfma_f32_16x16x32_bf16 v[124:127], v[44:47], v[100:103], v[124:127]
    ds_read_b64_tr_b16 v[62:63], v15 offset:45568
    s_waitcnt lgkmcnt(6)
    v_mfma_f32_16x16x32_bf16 v[136:139], v[48:51], v[88:91], v[136:139]
    s_waitcnt lgkmcnt(4)
    v_mfma_f32_16x16x32_bf16 v[136:139], v[52:55], v[100:103], v[136:139]
    v_mfma_f32_16x16x32_bf16 v[140:143], v[48:51], v[92:95], v[140:143]
    s_waitcnt lgkmcnt(0)
    s_barrier
    v_mfma_f32_16x16x32_bf16 v[140:143], v[52:55], v[104:107], v[140:143]
    ds_read_b128 v[64:67], v18 offset:24576
    ds_read_b128 v[76:79], v19 offset:24576
    v_mfma_f32_16x16x32_bf16 v[144:147], v[48:51], v[96:99], v[144:147]
    ds_read_b64_tr_b16 v[32:33], v12 offset:53248
    ds_read_b64_tr_b16 v[34:35], v12 offset:53760
    v_mfma_f32_16x16x32_bf16 v[144:147], v[52:55], v[108:111], v[144:147]
    ds_read_b64_tr_b16 v[36:37], v12 offset:61440
    ds_read_b64_tr_b16 v[38:39], v12 offset:61952
    v_mfma_f32_16x16x32_bf16 v[156:159], v[56:59], v[96:99], v[156:159]
    ds_read_b64_tr_b16 v[40:41], v13 offset:53248
    ds_read_b64_tr_b16 v[42:43], v13 offset:53760
    v_mfma_f32_16x16x32_bf16 v[156:159], v[60:63], v[108:111], v[156:159]
    ds_read_b64_tr_b16 v[44:45], v13 offset:61440
    ds_read_b64_tr_b16 v[46:47], v13 offset:61952
    v_mfma_f32_16x16x32_bf16 v[152:155], v[56:59], v[92:95], v[152:155]
    ds_read_b64_tr_b16 v[176:177], v14 offset:53248
    ds_read_b64_tr_b16 v[178:179], v14 offset:53760
    v_mfma_f32_16x16x32_bf16 v[152:155], v[60:63], v[104:107], v[152:155]
    ds_read_b64_tr_b16 v[180:181], v14 offset:61440
    v_mfma_f32_16x16x32_bf16 v[148:151], v[56:59], v[88:91], v[148:151]
    ds_read_b64_tr_b16 v[182:183], v14 offset:61952
    v_mfma_f32_16x16x32_bf16 v[148:151], v[60:63], v[100:103], v[148:151]
    ds_read_b64_tr_b16 v[184:185], v15 offset:53248
    s_waitcnt lgkmcnt(11)
    v_mfma_f32_16x16x32_bf16 v[112:115], v[32:35], v[64:67], v[112:115]
    ds_read_b64_tr_b16 v[186:187], v15 offset:53760
    s_waitcnt lgkmcnt(10)
    v_mfma_f32_16x16x32_bf16 v[112:115], v[36:39], v[76:79], v[112:115]
    ds_read_b64_tr_b16 v[188:189], v15 offset:61440
    s_waitcnt lgkmcnt(9)
    v_mfma_f32_16x16x32_bf16 v[124:127], v[40:43], v[64:67], v[124:127]
    ds_read_b64_tr_b16 v[190:191], v15 offset:61952
    s_waitcnt lgkmcnt(8)
    v_mfma_f32_16x16x32_bf16 v[124:127], v[44:47], v[76:79], v[124:127]
    ds_read_b128 v[68:71], v18 offset:26624
    s_waitcnt lgkmcnt(7)
    v_mfma_f32_16x16x32_bf16 v[136:139], v[176:179], v[64:67], v[136:139]
    ds_read_b128 v[80:83], v19 offset:26624
    s_waitcnt lgkmcnt(6)
    v_mfma_f32_16x16x32_bf16 v[136:139], v[180:183], v[76:79], v[136:139]
    ds_read_b128 v[72:75], v18 offset:28672
    v_cvt_pk_bf16_f32 v160, v112, v113
    s_waitcnt lgkmcnt(5)
    v_mfma_f32_16x16x32_bf16 v[148:151], v[184:187], v[64:67], v[148:151]
    ds_read_b128 v[84:87], v19 offset:28672
    v_cvt_pk_bf16_f32 v161, v114, v115
    s_waitcnt lgkmcnt(4)
    v_mfma_f32_16x16x32_bf16 v[148:151], v[188:191], v[76:79], v[148:151]
    ds_write_b64 v3, v[160:161] offset:0
    v_cvt_pk_bf16_f32 v162, v124, v125
    s_waitcnt lgkmcnt(4)
    v_mfma_f32_16x16x32_bf16 v[116:119], v[32:35], v[68:71], v[116:119]
    v_cvt_pk_bf16_f32 v163, v126, v127
    s_waitcnt lgkmcnt(3)
    v_mfma_f32_16x16x32_bf16 v[116:119], v[36:39], v[80:83], v[116:119]
    ds_write_b64 v3, v[162:163] offset:256
    v_cvt_pk_bf16_f32 v164, v136, v137
    v_mfma_f32_16x16x32_bf16 v[128:131], v[40:43], v[68:71], v[128:131]
    v_cvt_pk_bf16_f32 v165, v138, v139
    v_mfma_f32_16x16x32_bf16 v[128:131], v[44:47], v[80:83], v[128:131]
    ds_write_b64 v3, v[164:165] offset:1024
    v_cvt_pk_bf16_f32 v166, v148, v149
    v_mfma_f32_16x16x32_bf16 v[140:143], v[176:179], v[68:71], v[140:143]
    v_cvt_pk_bf16_f32 v167, v150, v151
    v_mfma_f32_16x16x32_bf16 v[140:143], v[180:183], v[80:83], v[140:143]
    ds_write_b64 v3, v[166:167] offset:1280
    v_cvt_pk_bf16_f32 v168, v116, v117
    v_mfma_f32_16x16x32_bf16 v[152:155], v[184:187], v[68:71], v[152:155]
    v_cvt_pk_bf16_f32 v169, v118, v119
    v_mfma_f32_16x16x32_bf16 v[152:155], v[188:191], v[80:83], v[152:155]
    ds_write_b64 v3, v[168:169] offset:4096
    v_cvt_pk_bf16_f32 v170, v128, v129
    s_waitcnt lgkmcnt(6)
    v_mfma_f32_16x16x32_bf16 v[120:123], v[32:35], v[72:75], v[120:123]
    v_cvt_pk_bf16_f32 v171, v130, v131
    s_waitcnt lgkmcnt(1)
    s_barrier
    v_mfma_f32_16x16x32_bf16 v[120:123], v[36:39], v[84:87], v[120:123]
    ds_write_b64 v3, v[170:171] offset:4352
    v_cvt_pk_bf16_f32 v172, v140, v141
    v_mfma_f32_16x16x32_bf16 v[132:135], v[40:43], v[72:75], v[132:135]
    v_cvt_pk_bf16_f32 v173, v142, v143
    v_mfma_f32_16x16x32_bf16 v[132:135], v[44:47], v[84:87], v[132:135]
    ds_write_b64 v3, v[172:173] offset:5120
    v_cvt_pk_bf16_f32 v174, v152, v153
    v_mfma_f32_16x16x32_bf16 v[144:147], v[176:179], v[72:75], v[144:147]
    v_cvt_pk_bf16_f32 v175, v154, v155
    v_mfma_f32_16x16x32_bf16 v[144:147], v[180:183], v[84:87], v[144:147]
    ds_write_b64 v3, v[174:175] offset:5376
    v_cvt_pk_bf16_f32 v160, v120, v121
    v_mfma_f32_16x16x32_bf16 v[156:159], v[184:187], v[72:75], v[156:159]
    v_cvt_pk_bf16_f32 v161, v122, v123
    v_mfma_f32_16x16x32_bf16 v[156:159], v[188:191], v[84:87], v[156:159]
    ds_write_b64 v3, v[160:161] offset:8192
    v_cvt_pk_bf16_f32 v162, v132, v133
    v_cvt_pk_bf16_f32 v163, v134, v135
    ds_write_b64 v3, v[162:163] offset:8448
    v_cvt_pk_bf16_f32 v164, v144, v145
    v_cvt_pk_bf16_f32 v165, v146, v147
    ds_write_b64 v3, v[164:165] offset:9216
    s_nop 0
    v_cvt_pk_bf16_f32 v166, v156, v157
    v_cvt_pk_bf16_f32 v167, v158, v159
    ds_write_b64 v3, v[166:167] offset:9472
    s_waitcnt lgkmcnt(0)
    s_barrier
    ds_read2st64_b64 v[160:163], v2 offset0:0 offset1:1
    ds_read_b128 v[204:207], v20 offset:0
    ds_read2st64_b64 v[164:167], v2 offset0:2 offset1:3
    ds_read_b128 v[216:219], v21 offset:0
    ds_read2st64_b64 v[168:171], v2 offset0:4 offset1:5
    ds_read_b128 v[228:231], v22 offset:0
    ds_read2st64_b64 v[172:175], v2 offset0:6 offset1:7
    ds_read_b128 v[240:243], v23 offset:0
    ds_read_b128 v[244:247], v23 offset:4096
    ds_read_b128 v[232:235], v22 offset:4096
    ds_read_b128 v[220:223], v21 offset:4096
    ds_read_b128 v[208:211], v20 offset:4096
    ds_read_b128 v[212:215], v20 offset:8192
    ds_read_b128 v[224:227], v21 offset:8192
    ds_read_b128 v[236:239], v22 offset:8192
    ds_read_b128 v[248:251], v23 offset:8192
    v_add_u32 v20, 24576, v20
    v_add_u32 v21, 24576, v21
    v_add_u32 v22, 24576, v22
    v_add_u32 v23, 24576, v23
    s_waitcnt lgkmcnt(14)
    v_mfma_f32_16x16x32_bf16 v[176:179], v[204:207], v[160:163], 0
    ds_read_b128 v[64:67], v20 offset:0
    s_waitcnt lgkmcnt(13)
    v_mfma_f32_16x16x32_bf16 v[176:179], v[216:219], v[164:167], v[176:179]
    ds_read_b128 v[68:71], v20 offset:4096
    s_waitcnt lgkmcnt(12)
    v_mfma_f32_16x16x32_bf16 v[176:179], v[228:231], v[168:171], v[176:179]
    ds_read_b128 v[72:75], v20 offset:8192
    s_waitcnt lgkmcnt(11)
    v_mfma_f32_16x16x32_bf16 v[176:179], v[240:243], v[172:175], v[176:179]
    ds_read_b128 v[76:79], v21 offset:0
    s_waitcnt lgkmcnt(11)
    v_mfma_f32_16x16x32_bf16 v[180:183], v[244:247], v[172:175], 0
    ds_read_b128 v[80:83], v21 offset:4096
    s_waitcnt lgkmcnt(11)
    v_mfma_f32_16x16x32_bf16 v[180:183], v[232:235], v[168:171], v[180:183]
    ds_read_b128 v[84:87], v21 offset:8192
    s_waitcnt lgkmcnt(11)
    v_mfma_f32_16x16x32_bf16 v[180:183], v[220:223], v[164:167], v[180:183]
    ds_read_b128 v[88:91], v22 offset:0
    s_waitcnt lgkmcnt(11)
    v_mfma_f32_16x16x32_bf16 v[180:183], v[208:211], v[160:163], v[180:183]
    ds_read_b128 v[92:95], v22 offset:4096
    s_waitcnt lgkmcnt(11)
    v_mfma_f32_16x16x32_bf16 v[184:187], v[212:215], v[160:163], 0
    ds_read_b128 v[96:99], v22 offset:8192
    s_waitcnt lgkmcnt(11)
    v_mfma_f32_16x16x32_bf16 v[184:187], v[224:227], v[164:167], v[184:187]
    ds_read_b128 v[100:103], v23 offset:0
    s_waitcnt lgkmcnt(11)
    v_mfma_f32_16x16x32_bf16 v[184:187], v[236:239], v[168:171], v[184:187]
    ds_read_b128 v[104:107], v23 offset:4096
    s_waitcnt lgkmcnt(11)
    v_mfma_f32_16x16x32_bf16 v[184:187], v[248:251], v[172:175], v[184:187]
    ds_read_b128 v[108:111], v23 offset:8192
    v_max3_f32 v24, v176, v177, v178
    v_max3_f32 v25, v179, v180, v181
    v_max3_f32 v24, v24, v182, v183
    s_nop 3
    v_max3_f32 v25, v25, v184, v185
    v_max3_f32 v24, v24, v186, v187
    v_max_f32 v24, v24, v25
    v_mov_b32 v25, v24
    s_nop 1
    v_permlane32_swap_b32 v24, v25
    v_max_f32 v24, v24, v25
    v_mov_b32 v25, v24
    s_nop 1
    v_permlane16_swap_b32 v24, v25
    v_max_f32 v24, v24, v25
    v_mul_f32 v24, s101, v24
    v_pk_fma_f32 v[176:177], v[176:177], s[100:101], v[24:25] op_sel_hi:[1,0,0]
    v_pk_fma_f32 v[178:179], v[178:179], s[100:101], v[24:25] op_sel_hi:[1,0,0]
    v_pk_fma_f32 v[180:181], v[180:181], s[100:101], v[24:25] op_sel_hi:[1,0,0]
    v_pk_fma_f32 v[182:183], v[182:183], s[100:101], v[24:25] op_sel_hi:[1,0,0]
    v_pk_fma_f32 v[184:185], v[184:185], s[100:101], v[24:25] op_sel_hi:[1,0,0]
    v_pk_fma_f32 v[186:187], v[186:187], s[100:101], v[24:25] op_sel_hi:[1,0,0]
    v_exp_f32 v176, v176
    v_exp_f32 v177, v177
    v_exp_f32 v178, v178
    v_exp_f32 v179, v179
    v_exp_f32 v180, v180
    v_pk_add_f32 v[26:27], v[176:177], v[178:179]
    v_exp_f32 v181, v181
    v_exp_f32 v182, v182
    v_pk_add_f32 v[26:27], v[26:27], v[180:181]
    v_exp_f32 v183, v183
    v_exp_f32 v184, v184
    v_pk_add_f32 v[26:27], v[26:27], v[182:183]
    v_exp_f32 v185, v185
    v_exp_f32 v186, v186
    v_pk_add_f32 v[26:27], v[26:27], v[184:185]
    v_exp_f32 v187, v187
    s_nop 0
    v_pk_add_f32 v[26:27], v[26:27], v[186:187]
    v_add_f32 v25, v26, v27
    v_mov_b32 v26, v25
    s_nop 1
    v_permlane32_swap_b32 v25, v26
    v_add_f32 v25, v25, v26
    v_mov_b32 v26, v25
    s_nop 1
    v_permlane16_swap_b32 v25, v26
    v_add_f32 v25, v25, v26
    v_rcp_f32 v24, v25
    s_nop 0
    v_pk_mul_f32 v[176:177], v[176:177], v[24:25] op_sel_hi:[1,0]
    v_pk_mul_f32 v[178:179], v[178:179], v[24:25] op_sel_hi:[1,0]
    v_pk_mul_f32 v[180:181], v[180:181], v[24:25] op_sel_hi:[1,0]
    v_pk_mul_f32 v[182:183], v[182:183], v[24:25] op_sel_hi:[1,0]
    v_pk_mul_f32 v[184:185], v[184:185], v[24:25] op_sel_hi:[1,0]
    v_pk_mul_f32 v[186:187], v[186:187], v[24:25] op_sel_hi:[1,0]
    v_cvt_pk_bf16_f32 v188, v176, v177
    v_cvt_pk_bf16_f32 v189, v178, v179
    v_cvt_pk_bf16_f32 v190, v180, v181
    v_cvt_pk_bf16_f32 v191, v182, v183
    v_cvt_pk_bf16_f32 v192, v184, v185
    v_cvt_pk_bf16_f32 v193, v186, v187
    buffer_store_dwordx4 v[188:191], v4, s[24:27], s55 offen sc1
    buffer_store_dwordx2 v[192:193], v5, s[24:27], s55 offen offset:1024 sc1
    ds_write_b128 v4, v[188:191]
    ds_write_b64 v5, v[192:193] offset:1024
L_mark:
    s_waitcnt lgkmcnt(0)
    s_barrier
    ds_read_b64_tr_b16 v[32:33], v16 offset:0
    ds_read_b64_tr_b16 v[34:35], v16 offset:512
    ds_read_b64_tr_b16 v[36:37], v16 offset:4096
    ds_read_b64_tr_b16 v[38:39], v16 offset:4608
    ds_read_b64_tr_b16 v[40:41], v16 offset:8192
    ds_read_b64_tr_b16 v[42:43], v16 offset:8704
    ds_read_b64_tr_b16 v[44:45], v16 offset:12288
    ds_read_b64_tr_b16 v[46:47], v16 offset:12800
    ds_read_b64_tr_b16 v[48:49], v17 offset:0
    ds_read_b64_tr_b16 v[50:51], v17 offset:512
    ds_read_b64_tr_b16 v[52:53], v17 offset:4096
    ds_read_b64_tr_b16 v[54:55], v17 offset:4608
    ds_read_b64_tr_b16 v[56:57], v17 offset:8192
    ds_read_b64_tr_b16 v[58:59], v17 offset:8704
    ds_read_b64_tr_b16 v[60:61], v17 offset:12288
    ds_read_b64_tr_b16 v[62:63], v17 offset:12800
    s_waitcnt lgkmcnt(14)
    v_mfma_f32_16x16x32_bf16 v[194:197], v[64:67], v[32:35], 0
    v_mov_b32 v238, 0
    v_mov_b32 v239, 0
    s_waitcnt lgkmcnt(12)
    v_mfma_f32_16x16x32_bf16 v[194:197], v[76:79], v[36:39], v[194:197]
    v_mov_b32 v246, 0
    v_mov_b32 v247, 0
    s_waitcnt lgkmcnt(10)
    v_mfma_f32_16x16x32_bf16 v[194:197], v[88:91], v[40:43], v[194:197]
    ds_read_b128 v[232:235], v6 offset:27648
    v_mov_b32 v254, 0
    s_waitcnt lgkmcnt(9)
    v_mfma_f32_16x16x32_bf16 v[194:197], v[100:103], v[44:47], v[194:197]
    ds_read_b64 v[236:237], v7 offset:28672
    v_mov_b32 v255, 0
    v_mfma_f32_16x16x32_bf16 v[198:201], v[104:107], v[44:47], 0
    ds_read_b128 v[240:243], v6 offset:29184
    v_mov_b32 v230, 0
    v_mfma_f32_16x16x32_bf16 v[198:201], v[92:95], v[40:43], v[198:201]
    ds_read_b64 v[244:245], v7 offset:30208
    v_mov_b32 v231, 0
    v_mfma_f32_16x16x32_bf16 v[198:201], v[80:83], v[36:39], v[198:201]
    ds_read_b128 v[248:251], v6 offset:30720
    v_mfma_f32_16x16x32_bf16 v[198:201], v[68:71], v[32:35], v[198:201]
    ds_read_b64 v[252:253], v7 offset:31744
    v_mfma_f32_16x16x32_bf16 v[202:205], v[72:75], v[32:35], 0
    v_mfma_f32_16x16x32_bf16 v[202:205], v[84:87], v[36:39], v[202:205]
    v_cvt_pk_bf16_f32 v218, v194, v195
    v_cvt_pk_bf16_f32 v219, v196, v197
    v_mfma_f32_16x16x32_bf16 v[202:205], v[96:99], v[40:43], v[202:205]
    v_mfma_f32_16x16x32_bf16 v[202:205], v[108:111], v[44:47], v[202:205]
    s_waitcnt lgkmcnt(0)
    s_barrier
    v_mfma_f32_16x16x32_bf16 v[206:209], v[64:67], v[48:51], 0
    ds_read_b64_tr_b16 v[32:33], v12 offset:20480
    v_mfma_f32_16x16x32_bf16 v[206:209], v[76:79], v[52:55], v[206:209]
    ds_read_b64_tr_b16 v[34:35], v12 offset:20992
    v_cvt_pk_bf16_f32 v220, v198, v199
    v_mfma_f32_16x16x32_bf16 v[206:209], v[88:91], v[56:59], v[206:209]
    ds_read_b64_tr_b16 v[36:37], v12 offset:28672
    v_cvt_pk_bf16_f32 v221, v200, v201
    v_mfma_f32_16x16x32_bf16 v[206:209], v[100:103], v[60:63], v[206:209]
    ds_read_b64_tr_b16 v[38:39], v12 offset:29184
    v_mfma_f32_16x16x32_bf16 v[210:213], v[104:107], v[60:63], 0
    ds_read_b64_tr_b16 v[40:41], v13 offset:20480
    v_mfma_f32_16x16x32_bf16 v[210:213], v[92:95], v[56:59], v[210:213]
    ds_read_b64_tr_b16 v[42:43], v13 offset:20992
    v_cvt_pk_bf16_f32 v222, v202, v203
    v_mfma_f32_16x16x32_bf16 v[210:213], v[80:83], v[52:55], v[210:213]
    ds_read_b64_tr_b16 v[44:45], v13 offset:28672
    v_cvt_pk_bf16_f32 v223, v204, v205
    v_mfma_f32_16x16x32_bf16 v[210:213], v[68:71], v[48:51], v[210:213]
    ds_read_b64_tr_b16 v[46:47], v13 offset:29184
    v_mfma_f32_16x16x32_bf16 v[214:217], v[72:75], v[48:51], 0
    v_mfma_f32_16x16x32_bf16 v[214:217], v[84:87], v[52:55], v[214:217]
    v_cvt_pk_bf16_f32 v224, v206, v207
    v_cvt_pk_bf16_f32 v225, v208, v209
    v_mfma_f32_16x16x32_bf16 v[214:217], v[96:99], v[56:59], v[214:217]
    v_mfma_f32_16x16x32_bf16 v[214:217], v[108:111], v[60:63], v[214:217]
    s_waitcnt lgkmcnt(0)
    v_mfma_f32_16x16x32_bf16 v[112:115], v[64:67], v[32:35], 0
    ds_read_b64_tr_b16 v[48:49], v14 offset:20480
    v_mfma_f32_16x16x32_bf16 v[112:115], v[76:79], v[36:39], v[112:115]
    ds_read_b64_tr_b16 v[50:51], v14 offset:20992
    v_cvt_pk_bf16_f32 v226, v210, v211
    v_mfma_f32_16x16x32_bf16 v[116:119], v[68:71], v[32:35], 0
    ds_read_b64_tr_b16 v[52:53], v14 offset:28672
    v_cvt_pk_bf16_f32 v227, v212, v213
    v_mfma_f32_16x16x32_bf16 v[116:119], v[80:83], v[36:39], v[116:119]
    ds_read_b64_tr_b16 v[54:55], v14 offset:29184
    v_mfma_f32_16x16x32_bf16 v[120:123], v[72:75], v[32:35], 0
    ds_read_b64_tr_b16 v[56:57], v15 offset:20480
    v_mfma_f32_16x16x32_bf16 v[120:123], v[84:87], v[36:39], v[120:123]
    ds_read_b64_tr_b16 v[58:59], v15 offset:20992
    v_cvt_pk_bf16_f32 v228, v214, v215
    v_mfma_f32_16x16x32_bf16 v[132:135], v[72:75], v[40:43], 0
    ds_read_b64_tr_b16 v[60:61], v15 offset:28672
    v_cvt_pk_bf16_f32 v229, v216, v217
    v_mfma_f32_16x16x32_bf16 v[132:135], v[84:87], v[44:47], v[132:135]
    ds_read_b64_tr_b16 v[62:63], v15 offset:29184
    v_mfma_f32_16x16x32_bf16 v[128:131], v[68:71], v[40:43], 0
    v_mfma_f32_16x16x32_bf16 v[128:131], v[80:83], v[44:47], v[128:131]
    v_mfma_f32_16x16x32_bf16 v[124:127], v[64:67], v[40:43], 0
    v_mfma_f32_16x16x32_bf16 v[124:127], v[76:79], v[44:47], v[124:127]
    v_mfma_f32_16x16x32_bf16 v[194:197], v[232:235], v[218:221], 0
    v_mfma_f32_16x16x32_bf16 v[194:197], v[236:239], v[222:225], v[194:197]
    v_mfma_f32_16x16x32_bf16 v[198:201], v[240:243], v[218:221], 0
    v_mfma_f32_16x16x32_bf16 v[198:201], v[244:247], v[222:225], v[198:201]
    v_mfma_f32_16x16x32_bf16 v[202:205], v[248:251], v[218:221], 0
    v_mfma_f32_16x16x32_bf16 v[202:205], v[252:255], v[222:225], v[202:205]
    v_mfma_f32_16x16x32_bf16 v[214:217], v[248:251], v[224:227], 0
    v_mfma_f32_16x16x32_bf16 v[214:217], v[252:255], v[228:231], v[214:217]
    v_mfma_f32_16x16x32_bf16 v[210:213], v[240:243], v[224:227], 0
    v_mfma_f32_16x16x32_bf16 v[210:213], v[244:247], v[228:231], v[210:213]
    v_mfma_f32_16x16x32_bf16 v[206:209], v[232:235], v[224:227], 0
    v_mfma_f32_16x16x32_bf16 v[206:209], v[236:239], v[228:231], v[206:209]
    s_barrier
    s_waitcnt lgkmcnt(0)
    v_mfma_f32_16x16x32_bf16 v[136:139], v[64:67], v[48:51], 0
    ds_read_b64_tr_b16 v[32:33], v12 offset:36864
    v_mfma_f32_16x16x32_bf16 v[136:139], v[76:79], v[52:55], v[136:139]
    ds_read_b64_tr_b16 v[34:35], v12 offset:37376
    v_mfma_f32_16x16x32_bf16 v[140:143], v[68:71], v[48:51], 0
    ds_read_b64_tr_b16 v[36:37], v12 offset:45056
    v_mfma_f32_16x16x32_bf16 v[140:143], v[80:83], v[52:55], v[140:143]
    ds_read_b64_tr_b16 v[38:39], v12 offset:45568
    v_mfma_f32_16x16x32_bf16 v[144:147], v[72:75], v[48:51], 0
    ds_read_b64_tr_b16 v[40:41], v13 offset:36864
    v_cvt_pk_bf16_f32 v16, v194, v195
    v_mfma_f32_16x16x32_bf16 v[144:147], v[84:87], v[52:55], v[144:147]
    ds_read_b64_tr_b16 v[42:43], v13 offset:37376
    v_cvt_pk_bf16_f32 v17, v196, v197
    v_mfma_f32_16x16x32_bf16 v[156:159], v[72:75], v[56:59], 0
    ds_read_b64_tr_b16 v[44:45], v13 offset:45056
    v_cvt_pk_bf16_f32 v18, v206, v207
    v_mfma_f32_16x16x32_bf16 v[156:159], v[84:87], v[60:63], v[156:159]
    ds_read_b64_tr_b16 v[46:47], v13 offset:45568
    v_cvt_pk_bf16_f32 v19, v208, v209
    v_mfma_f32_16x16x32_bf16 v[152:155], v[68:71], v[56:59], 0
    v_cvt_pk_bf16_f32 v24, v198, v199
    v_cvt_pk_bf16_f32 v25, v200, v201
    v_mfma_f32_16x16x32_bf16 v[152:155], v[80:83], v[60:63], v[152:155]
    v_cvt_pk_bf16_f32 v26, v210, v211
    v_cvt_pk_bf16_f32 v27, v212, v213
    v_mfma_f32_16x16x32_bf16 v[148:151], v[64:67], v[56:59], 0
    v_mfma_f32_16x16x32_bf16 v[148:151], v[76:79], v[60:63], v[148:151]
    s_waitcnt lgkmcnt(0)
    v_mfma_f32_16x16x32_bf16 v[112:115], v[88:91], v[32:35], v[112:115]
    ds_read_b64_tr_b16 v[48:49], v14 offset:36864
    v_cvt_pk_bf16_f32 v28, v202, v203
    v_mfma_f32_16x16x32_bf16 v[112:115], v[100:103], v[36:39], v[112:115]
    ds_read_b64_tr_b16 v[50:51], v14 offset:37376
    v_cvt_pk_bf16_f32 v29, v204, v205
    v_mfma_f32_16x16x32_bf16 v[116:119], v[92:95], v[32:35], v[116:119]
    ds_read_b64_tr_b16 v[52:53], v14 offset:45056
    v_cvt_pk_bf16_f32 v30, v214, v215
    v_mfma_f32_16x16x32_bf16 v[116:119], v[104:107], v[36:39], v[116:119]
    ds_read_b64_tr_b16 v[54:55], v14 offset:45568
    v_cvt_pk_bf16_f32 v31, v216, v217
    v_mfma_f32_16x16x32_bf16 v[120:123], v[96:99], v[32:35], v[120:123]
    ds_read_b64_tr_b16 v[56:57], v15 offset:36864
    v_mfma_f32_16x16x32_bf16 v[120:123], v[108:111], v[36:39], v[120:123]
    ds_read_b64_tr_b16 v[58:59], v15 offset:37376
    v_mfma_f32_16x16x32_bf16 v[132:135], v[96:99], v[40:43], v[132:135]
    ds_read_b64_tr_b16 v[60:61], v15 offset:45056
    v_cvt_pk_bf16_f32 v160, v112, v113
    v_mfma_f32_16x16x32_bf16 v[132:135], v[108:111], v[44:47], v[132:135]
    ds_read_b64_tr_b16 v[62:63], v15 offset:45568
    v_cvt_pk_bf16_f32 v161, v114, v115
    v_mfma_f32_16x16x32_bf16 v[128:131], v[92:95], v[40:43], v[128:131]
    v_cvt_pk_bf16_f32 v162, v116, v117
    v_cvt_pk_bf16_f32 v163, v118, v119
    v_mfma_f32_16x16x32_bf16 v[128:131], v[104:107], v[44:47], v[128:131]
    v_mfma_f32_16x16x32_bf16 v[124:127], v[88:91], v[40:43], v[124:127]
    v_cvt_pk_bf16_f32 v164, v120, v121
    v_cvt_pk_bf16_f32 v165, v122, v123
    v_mfma_f32_16x16x32_bf16 v[124:127], v[100:103], v[44:47], v[124:127]
    s_waitcnt vmcnt(0) lgkmcnt(0)
    s_barrier
    v_mfma_f32_16x16x32_bf16 v[136:139], v[88:91], v[48:51], v[136:139]
    ds_read_b64_tr_b16 v[32:33], v12 offset:53248
    v_cvt_pk_bf16_f32 v188, v132, v133
    v_mfma_f32_16x16x32_bf16 v[136:139], v[100:103], v[52:55], v[136:139]
    ds_read_b64_tr_b16 v[34:35], v12 offset:53760
    v_cvt_pk_bf16_f32 v189, v134, v135
    v_mfma_f32_16x16x32_bf16 v[140:143], v[92:95], v[48:51], v[140:143]
    ds_read_b64_tr_b16 v[36:37], v12 offset:61440
    v_cvt_pk_bf16_f32 v186, v128, v129
    v_mfma_f32_16x16x32_bf16 v[140:143], v[104:107], v[52:55], v[140:143]
    ds_read_b64_tr_b16 v[38:39], v12 offset:61952
    v_cvt_pk_bf16_f32 v187, v130, v131
    v_mfma_f32_16x16x32_bf16 v[144:147], v[96:99], v[48:51], v[144:147]
    ds_read_b64_tr_b16 v[40:41], v8 offset:24576
    v_cvt_pk_bf16_f32 v184, v124, v125
    v_mfma_f32_16x16x32_bf16 v[144:147], v[108:111], v[52:55], v[144:147]
    ds_read_b64_tr_b16 v[42:43], v8 offset:25088
    v_cvt_pk_bf16_f32 v185, v126, v127
    v_mfma_f32_16x16x32_bf16 v[156:159], v[96:99], v[56:59], v[156:159]
    ds_read_b64_tr_b16 v[44:45], v8 offset:32768
    v_cvt_pk_bf16_f32 v208, v136, v137
    v_mfma_f32_16x16x32_bf16 v[156:159], v[108:111], v[60:63], v[156:159]
    ds_read_b64_tr_b16 v[46:47], v8 offset:33280
    v_cvt_pk_bf16_f32 v209, v138, v139
    v_mfma_f32_16x16x32_bf16 v[152:155], v[92:95], v[56:59], v[152:155]
    v_cvt_pk_bf16_f32 v210, v140, v141
    v_cvt_pk_bf16_f32 v211, v142, v143
    v_mfma_f32_16x16x32_bf16 v[152:155], v[104:107], v[60:63], v[152:155]
    v_mfma_f32_16x16x32_bf16 v[148:151], v[88:91], v[56:59], v[148:151]
    v_cvt_pk_bf16_f32 v212, v144, v145
    v_cvt_pk_bf16_f32 v213, v146, v147
    v_mfma_f32_16x16x32_bf16 v[148:151], v[100:103], v[60:63], v[148:151]
    s_waitcnt lgkmcnt(0)
    v_mfma_f32_16x16x32_bf16 v[112:115], v[64:67], v[32:35], 0
    ds_read_b64_tr_b16 v[48:49], v13 offset:53248
    v_cvt_pk_bf16_f32 v236, v156, v157
    v_mfma_f32_16x16x32_bf16 v[112:115], v[76:79], v[36:39], v[112:115]
    ds_read_b64_tr_b16 v[50:51], v13 offset:53760
    v_cvt_pk_bf16_f32 v237, v158, v159
    v_mfma_f32_16x16x32_bf16 v[112:115], v[88:91], v[40:43], v[112:115]
    ds_read_b64_tr_b16 v[52:53], v13 offset:61440
    v_cvt_pk_bf16_f32 v234, v152, v153
    v_mfma_f32_16x16x32_bf16 v[112:115], v[100:103], v[44:47], v[112:115]
    ds_read_b64_tr_b16 v[54:55], v13 offset:61952
    v_cvt_pk_bf16_f32 v235, v154, v155
    v_mfma_f32_16x16x32_bf16 v[116:119], v[104:107], v[44:47], 0
    ds_read_b64_tr_b16 v[56:57], v9 offset:24576
    v_cvt_pk_bf16_f32 v232, v148, v149
    v_mfma_f32_16x16x32_bf16 v[116:119], v[92:95], v[40:43], v[116:119]
    ds_read_b64_tr_b16 v[58:59], v9 offset:25088
    v_cvt_pk_bf16_f32 v233, v150, v151
    v_mfma_f32_16x16x32_bf16 v[116:119], v[80:83], v[36:39], v[116:119]
    ds_read_b64_tr_b16 v[60:61], v9 offset:32768
    v_mfma_f32_16x16x32_bf16 v[116:119], v[68:71], v[32:35], v[116:119]
    ds_read_b64_tr_b16 v[62:63], v9 offset:33280
    v_mfma_f32_16x16x32_bf16 v[120:123], v[72:75], v[32:35], 0
    v_cvt_pk_bf16_f32 v168, v112, v113
    v_cvt_pk_bf16_f32 v169, v114, v115
    v_mfma_f32_16x16x32_bf16 v[120:123], v[84:87], v[36:39], v[120:123]
    v_mfma_f32_16x16x32_bf16 v[120:123], v[96:99], v[40:43], v[120:123]
    v_mfma_f32_16x16x32_bf16 v[120:123], v[108:111], v[44:47], v[120:123]
    s_waitcnt lgkmcnt(0)
    v_mfma_f32_16x16x32_bf16 v[124:127], v[64:67], v[48:51], 0
    ds_read_b64_tr_b16 v[32:33], v14 offset:53248
    v_cvt_pk_bf16_f32 v170, v116, v117
    v_mfma_f32_16x16x32_bf16 v[124:127], v[76:79], v[52:55], v[124:127]
    ds_read_b64_tr_b16 v[34:35], v14 offset:53760
    v_cvt_pk_bf16_f32 v171, v118, v119
    v_mfma_f32_16x16x32_bf16 v[124:127], v[88:91], v[56:59], v[124:127]
    ds_read_b64_tr_b16 v[36:37], v14 offset:61440
    v_mov_b32 v2, 1
    v_mfma_f32_16x16x32_bf16 v[124:127], v[100:103], v[60:63], v[124:127]
    ds_read_b64_tr_b16 v[38:39], v14 offset:61952
    v_mov_b32 v3, 0
    v_mfma_f32_16x16x32_bf16 v[128:131], v[104:107], v[60:63], 0
    ds_read_b64_tr_b16 v[40:41], v10 offset:24576
    v_cvt_pk_bf16_f32 v166, v120, v121
    v_mfma_f32_16x16x32_bf16 v[128:131], v[92:95], v[56:59], v[128:131]
    ds_read_b64_tr_b16 v[42:43], v10 offset:25088
    v_cvt_pk_bf16_f32 v167, v122, v123
    v_mfma_f32_16x16x32_bf16 v[128:131], v[80:83], v[52:55], v[128:131]
    ds_read_b64_tr_b16 v[44:45], v10 offset:32768
    v_lshrrev_b32 v4, 5, v0
    v_mfma_f32_16x16x32_bf16 v[128:131], v[68:71], v[48:51], v[128:131]
    ds_read_b64_tr_b16 v[46:47], v10 offset:33280
    v_add_u32 v4, s49, v4
    v_mfma_f32_16x16x32_bf16 v[132:135], v[72:75], v[48:51], 0
    v_cvt_pk_bf16_f32 v192, v124, v125
    v_cvt_pk_bf16_f32 v193, v126, v127
    v_mfma_f32_16x16x32_bf16 v[132:135], v[84:87], v[52:55], v[132:135]
    v_cmp_eq_u32 vcc, s37, v4
    v_mov_b32 v4, 0x7ff00000
    v_mfma_f32_16x16x32_bf16 v[132:135], v[96:99], v[56:59], v[132:135]
    v_add_u32 v5, s46, v1
    v_cndmask_b32 v4, v1, v4, vcc
    v_mfma_f32_16x16x32_bf16 v[132:135], v[108:111], v[60:63], v[132:135]
    s_waitcnt lgkmcnt(0)
    v_mfma_f32_16x16x32_bf16 v[136:139], v[64:67], v[32:35], 0
    ds_read_b64_tr_b16 v[48:49], v15 offset:53248
    v_cvt_pk_bf16_f32 v194, v128, v129
    v_mfma_f32_16x16x32_bf16 v[136:139], v[76:79], v[36:39], v[136:139]
    ds_read_b64_tr_b16 v[50:51], v15 offset:53760
    v_cvt_pk_bf16_f32 v195, v130, v131
    v_mfma_f32_16x16x32_bf16 v[136:139], v[88:91], v[40:43], v[136:139]
    ds_read_b64_tr_b16 v[52:53], v15 offset:61440
    v_mfma_f32_16x16x32_bf16 v[136:139], v[100:103], v[44:47], v[136:139]
    ds_read_b64_tr_b16 v[54:55], v15 offset:61952
    v_mfma_f32_16x16x32_bf16 v[140:143], v[104:107], v[44:47], 0
    ds_read_b64_tr_b16 v[56:57], v11 offset:24576
    v_cvt_pk_bf16_f32 v190, v132, v133
    v_mfma_f32_16x16x32_bf16 v[140:143], v[92:95], v[40:43], v[140:143]
    ds_read_b64_tr_b16 v[58:59], v11 offset:25088
    v_cvt_pk_bf16_f32 v191, v134, v135
    v_mfma_f32_16x16x32_bf16 v[140:143], v[80:83], v[36:39], v[140:143]
    ds_read_b64_tr_b16 v[60:61], v11 offset:32768
    v_mfma_f32_16x16x32_bf16 v[140:143], v[68:71], v[32:35], v[140:143]
    ds_read_b64_tr_b16 v[62:63], v11 offset:33280
    v_mfma_f32_16x16x32_bf16 v[144:147], v[72:75], v[32:35], 0
    v_cvt_pk_bf16_f32 v216, v136, v137
    v_cvt_pk_bf16_f32 v217, v138, v139
    v_mfma_f32_16x16x32_bf16 v[144:147], v[84:87], v[36:39], v[144:147]
    v_mfma_f32_16x16x32_bf16 v[144:147], v[96:99], v[40:43], v[144:147]
    v_mfma_f32_16x16x32_bf16 v[144:147], v[108:111], v[44:47], v[144:147]
    buffer_store_dwordx4 v[16:19], v1, s[24:27], s53 offen offset:0 sc1
    s_waitcnt lgkmcnt(0)
    s_barrier
    v_mfma_f32_16x16x32_bf16 v[148:151], v[64:67], v[48:51], 0
    ds_read_b64_tr_b16 v[32:33], v8 offset:40960
    ds_read_b64_tr_b16 v[34:35], v8 offset:41472
    v_mfma_f32_16x16x32_bf16 v[148:151], v[76:79], v[52:55], v[148:151]
    ds_read_b64_tr_b16 v[36:37], v8 offset:0
    ds_read_b64_tr_b16 v[38:39], v8 offset:512
    v_mfma_f32_16x16x32_bf16 v[148:151], v[88:91], v[56:59], v[148:151]
    ds_read_b64_tr_b16 v[40:41], v8 offset:8192
    v_cvt_pk_bf16_f32 v218, v140, v141
    v_mfma_f32_16x16x32_bf16 v[148:151], v[100:103], v[60:63], v[148:151]
    ds_read_b64_tr_b16 v[42:43], v8 offset:8704
    v_cvt_pk_bf16_f32 v219, v142, v143
    v_mfma_f32_16x16x32_bf16 v[152:155], v[104:107], v[60:63], 0
    ds_read_b64_tr_b16 v[44:45], v8 offset:16384
    ds_read_b128 v[64:67], v20 offset:0
    v_mfma_f32_16x16x32_bf16 v[152:155], v[92:95], v[56:59], v[152:155]
    ds_read_b64_tr_b16 v[46:47], v8 offset:16896
    v_cvt_pk_bf16_f32 v214, v144, v145
    v_mfma_f32_16x16x32_bf16 v[152:155], v[80:83], v[52:55], v[152:155]
    ds_read_b128 v[76:79], v21 offset:0
    v_cvt_pk_bf16_f32 v215, v146, v147
    v_mfma_f32_16x16x32_bf16 v[152:155], v[68:71], v[48:51], v[152:155]
    ds_read_b128 v[88:91], v22 offset:0
    v_mfma_f32_16x16x32_bf16 v[156:159], v[72:75], v[48:51], 0
    ds_read_b128 v[100:103], v23 offset:0
    v_cvt_pk_bf16_f32 v240, v148, v149
    v_mfma_f32_16x16x32_bf16 v[156:159], v[84:87], v[52:55], v[156:159]
    ds_read_b128 v[104:107], v23 offset:4096
    v_cvt_pk_bf16_f32 v241, v150, v151
    v_mfma_f32_16x16x32_bf16 v[156:159], v[96:99], v[56:59], v[156:159]
    ds_read_b128 v[92:95], v22 offset:4096
    v_mfma_f32_16x16x32_bf16 v[156:159], v[108:111], v[60:63], v[156:159]
    ds_read_b128 v[80:83], v21 offset:4096
    buffer_store_dwordx4 v[24:27], v1, s[24:27], s53 offen offset:1024 sc1
    s_waitcnt lgkmcnt(7)
    v_mfma_f32_16x16x32_bf16 v[112:115], v[64:67], v[32:35], 0
    ds_read_b128 v[68:71], v20 offset:4096
    ds_read_b64_tr_b16 v[48:49], v9 offset:40960
    s_waitcnt lgkmcnt(7)
    v_mfma_f32_16x16x32_bf16 v[112:115], v[76:79], v[36:39], v[112:115]
    ds_read_b128 v[72:75], v20 offset:8192
    v_cvt_pk_bf16_f32 v242, v152, v153
    s_waitcnt lgkmcnt(7)
    v_mfma_f32_16x16x32_bf16 v[112:115], v[88:91], v[40:43], v[112:115]
    ds_read_b128 v[84:87], v21 offset:8192
    v_cvt_pk_bf16_f32 v243, v154, v155
    s_waitcnt lgkmcnt(7)
    v_mfma_f32_16x16x32_bf16 v[112:115], v[100:103], v[44:47], v[112:115]
    ds_read_b128 v[96:99], v22 offset:8192
    s_waitcnt lgkmcnt(7)
    v_mfma_f32_16x16x32_bf16 v[116:119], v[104:107], v[44:47], 0
    ds_read_b128 v[108:111], v23 offset:8192
    v_cvt_pk_bf16_f32 v238, v156, v157
    s_waitcnt lgkmcnt(7)
    v_mfma_f32_16x16x32_bf16 v[116:119], v[92:95], v[40:43], v[116:119]
    ds_read_b64_tr_b16 v[50:51], v9 offset:41472
    v_cvt_pk_bf16_f32 v239, v158, v159
    s_waitcnt lgkmcnt(7)
    v_mfma_f32_16x16x32_bf16 v[116:119], v[80:83], v[36:39], v[116:119]
    ds_read_b64_tr_b16 v[52:53], v9 offset:0
    s_waitcnt lgkmcnt(7)
    v_mfma_f32_16x16x32_bf16 v[116:119], v[68:71], v[32:35], v[116:119]
    ds_read_b64_tr_b16 v[54:55], v9 offset:512
    s_waitcnt lgkmcnt(6)
    v_mfma_f32_16x16x32_bf16 v[120:123], v[72:75], v[32:35], 0
    ds_read_b64_tr_b16 v[56:57], v9 offset:8192
    v_cvt_pk_bf16_f32 v172, v112, v113
    s_waitcnt lgkmcnt(6)
    v_mfma_f32_16x16x32_bf16 v[120:123], v[84:87], v[36:39], v[120:123]
    ds_read_b64_tr_b16 v[58:59], v9 offset:8704
    v_cvt_pk_bf16_f32 v173, v114, v115
    s_waitcnt lgkmcnt(6)
    v_mfma_f32_16x16x32_bf16 v[120:123], v[96:99], v[40:43], v[120:123]
    ds_read_b64_tr_b16 v[60:61], v9 offset:16384
    s_waitcnt lgkmcnt(6)
    v_mfma_f32_16x16x32_bf16 v[120:123], v[108:111], v[44:47], v[120:123]
    ds_read_b64_tr_b16 v[62:63], v9 offset:16896
    buffer_store_dwordx4 v[28:31], v1, s[24:27], s53 offen offset:2048 sc1
    s_waitcnt lgkmcnt(6)
    v_mfma_f32_16x16x32_bf16 v[124:127], v[64:67], v[48:51], 0
    ds_read_b64_tr_b16 v[32:33], v10 offset:40960
    v_cvt_pk_bf16_f32 v174, v116, v117
    s_waitcnt lgkmcnt(5)
    v_mfma_f32_16x16x32_bf16 v[124:127], v[76:79], v[52:55], v[124:127]
    ds_read_b64_tr_b16 v[34:35], v10 offset:41472
    v_cvt_pk_bf16_f32 v175, v118, v119
    s_waitcnt lgkmcnt(4)
    v_mfma_f32_16x16x32_bf16 v[124:127], v[88:91], v[56:59], v[124:127]
    ds_read_b64_tr_b16 v[36:37], v10 offset:0
    s_waitcnt lgkmcnt(3)
    v_mfma_f32_16x16x32_bf16 v[124:127], v[100:103], v[60:63], v[124:127]
    ds_read_b64_tr_b16 v[38:39], v10 offset:512
    v_mfma_f32_16x16x32_bf16 v[128:131], v[104:107], v[60:63], 0
    ds_read_b64_tr_b16 v[40:41], v10 offset:8192
    v_cvt_pk_bf16_f32 v176, v120, v121
    v_mfma_f32_16x16x32_bf16 v[128:131], v[92:95], v[56:59], v[128:131]
    ds_read_b64_tr_b16 v[42:43], v10 offset:8704
    v_cvt_pk_bf16_f32 v177, v122, v123
    v_mfma_f32_16x16x32_bf16 v[128:131], v[80:83], v[52:55], v[128:131]
    ds_read_b64_tr_b16 v[44:45], v10 offset:16384
    v_mfma_f32_16x16x32_bf16 v[128:131], v[68:71], v[48:51], v[128:131]
    ds_read_b64_tr_b16 v[46:47], v10 offset:16896
    v_mfma_f32_16x16x32_bf16 v[132:135], v[72:75], v[48:51], 0
    v_cvt_pk_bf16_f32 v196, v124, v125
    v_cvt_pk_bf16_f32 v197, v126, v127
    v_mfma_f32_16x16x32_bf16 v[132:135], v[84:87], v[52:55], v[132:135]
    v_mfma_f32_16x16x32_bf16 v[132:135], v[96:99], v[56:59], v[132:135]
    v_mfma_f32_16x16x32_bf16 v[132:135], v[108:111], v[60:63], v[132:135]
    s_waitcnt lgkmcnt(0)
    v_mfma_f32_16x16x32_bf16 v[136:139], v[64:67], v[32:35], 0
    ds_read_b64_tr_b16 v[48:49], v11 offset:40960
    v_cvt_pk_bf16_f32 v198, v128, v129
    v_mfma_f32_16x16x32_bf16 v[136:139], v[76:79], v[36:39], v[136:139]
    ds_read_b64_tr_b16 v[50:51], v11 offset:41472
    v_cvt_pk_bf16_f32 v199, v130, v131
    v_mfma_f32_16x16x32_bf16 v[136:139], v[88:91], v[40:43], v[136:139]
    ds_read_b64_tr_b16 v[52:53], v11 offset:0
    v_mfma_f32_16x16x32_bf16 v[136:139], v[100:103], v[44:47], v[136:139]
    ds_read_b64_tr_b16 v[54:55], v11 offset:512
    v_mfma_f32_16x16x32_bf16 v[140:143], v[104:107], v[44:47], 0
    ds_read_b64_tr_b16 v[56:57], v11 offset:8192
    v_cvt_pk_bf16_f32 v200, v132, v133
    v_mfma_f32_16x16x32_bf16 v[140:143], v[92:95], v[40:43], v[140:143]
    ds_read_b64_tr_b16 v[58:59], v11 offset:8704
    v_cvt_pk_bf16_f32 v201, v134, v135
    v_mfma_f32_16x16x32_bf16 v[140:143], v[80:83], v[36:39], v[140:143]
    ds_read_b64_tr_b16 v[60:61], v11 offset:16384
    v_mfma_f32_16x16x32_bf16 v[140:143], v[68:71], v[32:35], v[140:143]
    ds_read_b64_tr_b16 v[62:63], v11 offset:16896
    v_mfma_f32_16x16x32_bf16 v[144:147], v[72:75], v[32:35], 0
    v_cvt_pk_bf16_f32 v220, v136, v137
    v_cvt_pk_bf16_f32 v221, v138, v139
    v_mfma_f32_16x16x32_bf16 v[144:147], v[84:87], v[36:39], v[144:147]
    v_mfma_f32_16x16x32_bf16 v[144:147], v[96:99], v[40:43], v[144:147]
    v_mfma_f32_16x16x32_bf16 v[144:147], v[108:111], v[44:47], v[144:147]
    s_waitcnt lgkmcnt(0)
    s_barrier
    v_mfma_f32_16x16x32_bf16 v[148:151], v[64:67], v[48:51], 0
    ds_read_b64_tr_b16 v[32:33], v12 offset:20480
    v_cvt_pk_bf16_f32 v222, v140, v141
    v_mfma_f32_16x16x32_bf16 v[148:151], v[76:79], v[52:55], v[148:151]
    ds_read_b64_tr_b16 v[34:35], v12 offset:20992
    v_cvt_pk_bf16_f32 v223, v142, v143
    v_mfma_f32_16x16x32_bf16 v[148:151], v[88:91], v[56:59], v[148:151]
    ds_read_b64_tr_b16 v[36:37], v12 offset:28672
    v_mfma_f32_16x16x32_bf16 v[148:151], v[100:103], v[60:63], v[148:151]
    ds_read_b64_tr_b16 v[38:39], v12 offset:29184
    v_mfma_f32_16x16x32_bf16 v[152:155], v[104:107], v[60:63], 0
    ds_read_b64_tr_b16 v[40:41], v12 offset:36864
    v_cvt_pk_bf16_f32 v224, v144, v145
    v_mfma_f32_16x16x32_bf16 v[152:155], v[92:95], v[56:59], v[152:155]
    ds_read_b64_tr_b16 v[42:43], v12 offset:37376
    v_cvt_pk_bf16_f32 v225, v146, v147
    v_mfma_f32_16x16x32_bf16 v[152:155], v[80:83], v[52:55], v[152:155]
    ds_read_b64_tr_b16 v[44:45], v12 offset:45056
    v_mfma_f32_16x16x32_bf16 v[152:155], v[68:71], v[48:51], v[152:155]
    ds_read_b64_tr_b16 v[46:47], v12 offset:45568
    v_mfma_f32_16x16x32_bf16 v[156:159], v[72:75], v[48:51], 0
    v_cvt_pk_bf16_f32 v244, v148, v149
    v_cvt_pk_bf16_f32 v245, v150, v151
    v_mfma_f32_16x16x32_bf16 v[156:159], v[84:87], v[52:55], v[156:159]
    v_mfma_f32_16x16x32_bf16 v[156:159], v[96:99], v[56:59], v[156:159]
    v_mfma_f32_16x16x32_bf16 v[156:159], v[108:111], v[60:63], v[156:159]
    s_waitcnt lgkmcnt(0)
    v_mfma_f32_16x16x32_bf16 v[112:115], v[64:67], v[32:35], 0
    ds_read_b64_tr_b16 v[48:49], v13 offset:20480
    v_cvt_pk_bf16_f32 v246, v152, v153
    v_mfma_f32_16x16x32_bf16 v[112:115], v[76:79], v[36:39], v[112:115]
    ds_read_b64_tr_b16 v[50:51], v13 offset:20992
    v_cvt_pk_bf16_f32 v247, v154, v155
    v_mfma_f32_16x16x32_bf16 v[112:115], v[88:91], v[40:43], v[112:115]
    ds_read_b64_tr_b16 v[52:53], v13 offset:28672
    v_mfma_f32_16x16x32_bf16 v[112:115], v[100:103], v[44:47], v[112:115]
    ds_read_b64_tr_b16 v[54:55], v13 offset:29184
    v_mfma_f32_16x16x32_bf16 v[116:119], v[104:107], v[44:47], 0
    ds_read_b64_tr_b16 v[56:57], v13 offset:36864
    v_cvt_pk_bf16_f32 v248, v156, v157
    v_mfma_f32_16x16x32_bf16 v[116:119], v[92:95], v[40:43], v[116:119]
    ds_read_b64_tr_b16 v[58:59], v13 offset:37376
    v_cvt_pk_bf16_f32 v249, v158, v159
    v_mfma_f32_16x16x32_bf16 v[116:119], v[80:83], v[36:39], v[116:119]
    ds_read_b64_tr_b16 v[60:61], v13 offset:45056
    v_mfma_f32_16x16x32_bf16 v[116:119], v[68:71], v[32:35], v[116:119]
    ds_read_b64_tr_b16 v[62:63], v13 offset:45568
    v_mfma_f32_16x16x32_bf16 v[120:123], v[72:75], v[32:35], 0
    v_cvt_pk_bf16_f32 v180, v112, v113
    v_cvt_pk_bf16_f32 v181, v114, v115
    v_mfma_f32_16x16x32_bf16 v[120:123], v[84:87], v[36:39], v[120:123]
    v_mfma_f32_16x16x32_bf16 v[120:123], v[96:99], v[40:43], v[120:123]
    s_waitcnt vmcnt(0)
    s_mov_b64 exec, 1
    buffer_store_dword v2, v3, s[24:27], s47 offen sc1
    s_mov_b64 exec, -1
    v_mfma_f32_16x16x32_bf16 v[120:123], v[108:111], v[44:47], v[120:123]
    s_waitcnt lgkmcnt(0)
    v_mfma_f32_16x16x32_bf16 v[124:127], v[64:67], v[48:51], 0
    ds_read_b64_tr_b16 v[32:33], v14 offset:20480
    v_cvt_pk_bf16_f32 v182, v116, v117
    v_mfma_f32_16x16x32_bf16 v[124:127], v[76:79], v[52:55], v[124:127]
    ds_read_b64_tr_b16 v[34:35], v14 offset:20992
    v_cvt_pk_bf16_f32 v183, v118, v119
    v_mfma_f32_16x16x32_bf16 v[124:127], v[88:91], v[56:59], v[124:127]
    ds_read_b64_tr_b16 v[36:37], v14 offset:28672
    v_mfma_f32_16x16x32_bf16 v[124:127], v[100:103], v[60:63], v[124:127]
    ds_read_b64_tr_b16 v[38:39], v14 offset:29184
    v_mfma_f32_16x16x32_bf16 v[128:131], v[104:107], v[60:63], 0
    ds_read_b64_tr_b16 v[40:41], v14 offset:36864
    v_cvt_pk_bf16_f32 v178, v120, v121
    v_mfma_f32_16x16x32_bf16 v[128:131], v[92:95], v[56:59], v[128:131]
    ds_read_b64_tr_b16 v[42:43], v14 offset:37376
    v_cvt_pk_bf16_f32 v179, v122, v123
    v_mfma_f32_16x16x32_bf16 v[128:131], v[80:83], v[52:55], v[128:131]
    ds_read_b64_tr_b16 v[44:45], v14 offset:45056
    v_mfma_f32_16x16x32_bf16 v[128:131], v[68:71], v[48:51], v[128:131]
    ds_read_b64_tr_b16 v[46:47], v14 offset:45568
    v_mfma_f32_16x16x32_bf16 v[132:135], v[72:75], v[48:51], 0
    v_cvt_pk_bf16_f32 v204, v124, v125
    v_cvt_pk_bf16_f32 v205, v126, v127
    v_mfma_f32_16x16x32_bf16 v[132:135], v[84:87], v[52:55], v[132:135]
    v_mfma_f32_16x16x32_bf16 v[132:135], v[96:99], v[56:59], v[132:135]
    v_mfma_f32_16x16x32_bf16 v[132:135], v[108:111], v[60:63], v[132:135]
    s_waitcnt lgkmcnt(0)
    v_mfma_f32_16x16x32_bf16 v[136:139], v[64:67], v[32:35], 0
    ds_read_b64_tr_b16 v[48:49], v15 offset:20480
    v_cvt_pk_bf16_f32 v206, v128, v129
    v_mfma_f32_16x16x32_bf16 v[136:139], v[76:79], v[36:39], v[136:139]
    ds_read_b64_tr_b16 v[50:51], v15 offset:20992
    v_cvt_pk_bf16_f32 v207, v130, v131
    v_mfma_f32_16x16x32_bf16 v[136:139], v[88:91], v[40:43], v[136:139]
    ds_read_b64_tr_b16 v[52:53], v15 offset:28672
    v_mfma_f32_16x16x32_bf16 v[136:139], v[100:103], v[44:47], v[136:139]
    ds_read_b64_tr_b16 v[54:55], v15 offset:29184
    v_mfma_f32_16x16x32_bf16 v[140:143], v[104:107], v[44:47], 0
    ds_read_b64_tr_b16 v[56:57], v15 offset:36864
    v_cvt_pk_bf16_f32 v202, v132, v133
    v_mfma_f32_16x16x32_bf16 v[140:143], v[92:95], v[40:43], v[140:143]
    ds_read_b64_tr_b16 v[58:59], v15 offset:37376
    v_cvt_pk_bf16_f32 v203, v134, v135
    v_mfma_f32_16x16x32_bf16 v[140:143], v[80:83], v[36:39], v[140:143]
    ds_read_b64_tr_b16 v[60:61], v15 offset:45056
    v_mfma_f32_16x16x32_bf16 v[140:143], v[68:71], v[32:35], v[140:143]
    ds_read_b64_tr_b16 v[62:63], v15 offset:45568
    v_mfma_f32_16x16x32_bf16 v[144:147], v[72:75], v[32:35], 0
    v_cvt_pk_bf16_f32 v228, v136, v137
    v_cvt_pk_bf16_f32 v229, v138, v139
    v_mfma_f32_16x16x32_bf16 v[144:147], v[84:87], v[36:39], v[144:147]
    v_mfma_f32_16x16x32_bf16 v[144:147], v[96:99], v[40:43], v[144:147]
    v_mfma_f32_16x16x32_bf16 v[144:147], v[108:111], v[44:47], v[144:147]
    s_waitcnt lgkmcnt(0)
    s_barrier
    v_mfma_f32_16x16x32_bf16 v[148:151], v[64:67], v[48:51], 0
    ds_read_b128 v[112:115], v6 offset:27648
    v_cvt_pk_bf16_f32 v230, v140, v141
    v_mfma_f32_16x16x32_bf16 v[148:151], v[76:79], v[52:55], v[148:151]
    ds_read_b64 v[116:117], v7 offset:28672
    v_cvt_pk_bf16_f32 v231, v142, v143
    v_mfma_f32_16x16x32_bf16 v[148:151], v[88:91], v[56:59], v[148:151]
    ds_read_b64 v[118:119], v7 offset:19456
    v_mfma_f32_16x16x32_bf16 v[148:151], v[100:103], v[60:63], v[148:151]
    ds_read_b128 v[120:123], v6 offset:18432
    v_mfma_f32_16x16x32_bf16 v[152:155], v[104:107], v[60:63], 0
    ds_read_b128 v[124:127], v6 offset:9216
    v_cvt_pk_bf16_f32 v226, v144, v145
    v_mfma_f32_16x16x32_bf16 v[152:155], v[92:95], v[56:59], v[152:155]
    ds_read_b64 v[128:129], v7 offset:10240
    v_cvt_pk_bf16_f32 v227, v146, v147
    v_mfma_f32_16x16x32_bf16 v[152:155], v[80:83], v[52:55], v[152:155]
    ds_read_b64 v[130:131], v7 offset:1024
    v_mfma_f32_16x16x32_bf16 v[152:155], v[68:71], v[48:51], v[152:155]
    ds_read_b128 v[132:135], v6 offset:0
    v_mfma_f32_16x16x32_bf16 v[156:159], v[72:75], v[48:51], 0
    v_cvt_pk_bf16_f32 v252, v148, v149
    v_cvt_pk_bf16_f32 v253, v150, v151
    v_mfma_f32_16x16x32_bf16 v[156:159], v[84:87], v[52:55], v[156:159]
    v_mfma_f32_16x16x32_bf16 v[156:159], v[96:99], v[56:59], v[156:159]
    v_mfma_f32_16x16x32_bf16 v[156:159], v[108:111], v[60:63], v[156:159]
    s_waitcnt lgkmcnt(0)
    v_mfma_f32_16x16x32_bf16 v[32:35], v[112:115], v[160:163], 0
    ds_read_b128 v[64:67], v6 offset:29184
    v_cvt_pk_bf16_f32 v254, v152, v153
    v_mfma_f32_16x16x32_bf16 v[32:35], v[116:119], v[164:167], v[32:35]
    ds_read_b64 v[68:69], v7 offset:30208
    v_cvt_pk_bf16_f32 v255, v154, v155
    v_mfma_f32_16x16x32_bf16 v[32:35], v[120:123], v[168:171], v[32:35]
    ds_read_b64 v[70:71], v7 offset:20992
    v_mfma_f32_16x16x32_bf16 v[32:35], v[124:127], v[172:175], v[32:35]
    ds_read_b128 v[72:75], v6 offset:19968
    v_mfma_f32_16x16x32_bf16 v[32:35], v[128:131], v[176:179], v[32:35]
    ds_read_b128 v[76:79], v6 offset:10752
    v_cvt_pk_bf16_f32 v250, v156, v157
    v_mfma_f32_16x16x32_bf16 v[32:35], v[132:135], v[180:183], v[32:35]
    ds_read_b64 v[80:81], v7 offset:11776
    v_cvt_pk_bf16_f32 v251, v158, v159
    v_mfma_f32_16x16x32_bf16 v[36:39], v[132:135], v[204:207], 0
    ds_read_b64 v[82:83], v7 offset:2560
    v_mfma_f32_16x16x32_bf16 v[36:39], v[128:131], v[200:203], v[36:39]
    ds_read_b128 v[84:87], v6 offset:1536
    v_mfma_f32_16x16x32_bf16 v[36:39], v[124:127], v[196:199], v[36:39]
    v_mfma_f32_16x16x32_bf16 v[36:39], v[120:123], v[192:195], v[36:39]
    v_mfma_f32_16x16x32_bf16 v[36:39], v[116:119], v[188:191], v[36:39]
    v_mfma_f32_16x16x32_bf16 v[36:39], v[112:115], v[184:187], v[36:39]
    v_mfma_f32_16x16x32_bf16 v[40:43], v[112:115], v[208:211], 0
    v_mfma_f32_16x16x32_bf16 v[40:43], v[116:119], v[212:215], v[40:43]
    v_mfma_f32_16x16x32_bf16 v[40:43], v[120:123], v[216:219], v[40:43]
    v_mfma_f32_16x16x32_bf16 v[40:43], v[124:127], v[220:223], v[40:43]
    v_mfma_f32_16x16x32_bf16 v[40:43], v[128:131], v[224:227], v[40:43]
    v_mfma_f32_16x16x32_bf16 v[40:43], v[132:135], v[228:231], v[40:43]
    v_mfma_f32_16x16x32_bf16 v[44:47], v[132:135], v[252:255], 0
    v_cvt_pk_bf16_f32 v32, v32, v33
    v_cvt_pk_bf16_f32 v33, v34, v35
    v_mfma_f32_16x16x32_bf16 v[44:47], v[128:131], v[248:251], v[44:47]
    v_cvt_pk_bf16_f32 v34, v36, v37
    v_cvt_pk_bf16_f32 v35, v38, v39
    v_mfma_f32_16x16x32_bf16 v[44:47], v[124:127], v[244:247], v[44:47]
    buffer_store_dwordx4 v[32:35], v4, s[24:27], s51 offen offset:0 sc1
    v_mfma_f32_16x16x32_bf16 v[44:47], v[120:123], v[240:243], v[44:47]
    v_mfma_f32_16x16x32_bf16 v[44:47], v[116:119], v[236:239], v[44:47]
    ds_write_b128 v5, v[32:35] offset:0
    v_mfma_f32_16x16x32_bf16 v[44:47], v[112:115], v[232:235], v[44:47]
    s_waitcnt lgkmcnt(1)
    v_mfma_f32_16x16x32_bf16 v[48:51], v[64:67], v[160:163], 0
    ds_read_b128 v[88:91], v6 offset:30720
    v_mfma_f32_16x16x32_bf16 v[48:51], v[68:71], v[164:167], v[48:51]
    ds_read_b64 v[92:93], v7 offset:31744
    v_mfma_f32_16x16x32_bf16 v[48:51], v[72:75], v[168:171], v[48:51]
    ds_read_b64 v[94:95], v7 offset:22528
    v_mfma_f32_16x16x32_bf16 v[48:51], v[76:79], v[172:175], v[48:51]
    ds_read_b128 v[96:99], v6 offset:21504
    v_mfma_f32_16x16x32_bf16 v[48:51], v[80:83], v[176:179], v[48:51]
    ds_read_b128 v[100:103], v6 offset:12288
    v_mfma_f32_16x16x32_bf16 v[48:51], v[84:87], v[180:183], v[48:51]
    ds_read_b64 v[104:105], v7 offset:13312
    v_mfma_f32_16x16x32_bf16 v[52:55], v[84:87], v[204:207], 0
    ds_read_b64 v[106:107], v7 offset:4096
    v_cvt_pk_bf16_f32 v40, v40, v41
    v_mfma_f32_16x16x32_bf16 v[52:55], v[80:83], v[200:203], v[52:55]
    ds_read_b128 v[108:111], v6 offset:3072
    v_cvt_pk_bf16_f32 v41, v42, v43
    v_mfma_f32_16x16x32_bf16 v[52:55], v[76:79], v[196:199], v[52:55]
    v_cvt_pk_bf16_f32 v42, v44, v45
    v_cvt_pk_bf16_f32 v43, v46, v47
    v_mfma_f32_16x16x32_bf16 v[52:55], v[72:75], v[192:195], v[52:55]
    buffer_store_dwordx4 v[40:43], v4, s[24:27], s51 offen offset:1024 sc1
    v_mfma_f32_16x16x32_bf16 v[52:55], v[68:71], v[188:191], v[52:55]
    v_mfma_f32_16x16x32_bf16 v[52:55], v[64:67], v[184:187], v[52:55]
    ds_write_b128 v5, v[40:43] offset:1024
    v_mfma_f32_16x16x32_bf16 v[56:59], v[64:67], v[208:211], 0
    v_mfma_f32_16x16x32_bf16 v[56:59], v[68:71], v[212:215], v[56:59]
    v_mfma_f32_16x16x32_bf16 v[56:59], v[72:75], v[216:219], v[56:59]
    v_mfma_f32_16x16x32_bf16 v[56:59], v[76:79], v[220:223], v[56:59]
    v_mfma_f32_16x16x32_bf16 v[56:59], v[80:83], v[224:227], v[56:59]
    v_mfma_f32_16x16x32_bf16 v[56:59], v[84:87], v[228:231], v[56:59]
    v_mfma_f32_16x16x32_bf16 v[60:63], v[84:87], v[252:255], 0
    v_cvt_pk_bf16_f32 v48, v48, v49
    v_cvt_pk_bf16_f32 v49, v50, v51
    v_mfma_f32_16x16x32_bf16 v[60:63], v[80:83], v[248:251], v[60:63]
    v_cvt_pk_bf16_f32 v50, v52, v53
    v_cvt_pk_bf16_f32 v51, v54, v55
    v_mfma_f32_16x16x32_bf16 v[60:63], v[76:79], v[244:247], v[60:63]
    buffer_store_dwordx4 v[48:51], v4, s[24:27], s51 offen offset:2048 sc1
    v_mfma_f32_16x16x32_bf16 v[60:63], v[72:75], v[240:243], v[60:63]
    v_mfma_f32_16x16x32_bf16 v[60:63], v[68:71], v[236:239], v[60:63]
    ds_write_b128 v5, v[48:51] offset:2048
    v_mfma_f32_16x16x32_bf16 v[60:63], v[64:67], v[232:235], v[60:63]
    s_waitcnt lgkmcnt(2)
    v_mfma_f32_16x16x32_bf16 v[136:139], v[88:91], v[160:163], 0
    v_mfma_f32_16x16x32_bf16 v[136:139], v[92:95], v[164:167], v[136:139]
    v_mfma_f32_16x16x32_bf16 v[136:139], v[96:99], v[168:171], v[136:139]
    v_mfma_f32_16x16x32_bf16 v[136:139], v[100:103], v[172:175], v[136:139]
    v_mfma_f32_16x16x32_bf16 v[136:139], v[104:107], v[176:179], v[136:139]
    v_mfma_f32_16x16x32_bf16 v[136:139], v[108:111], v[180:183], v[136:139]
    v_mfma_f32_16x16x32_bf16 v[140:143], v[108:111], v[204:207], 0
    v_cvt_pk_bf16_f32 v56, v56, v57
    v_cvt_pk_bf16_f32 v57, v58, v59
    v_mfma_f32_16x16x32_bf16 v[140:143], v[104:107], v[200:203], v[140:143]
    v_cvt_pk_bf16_f32 v58, v60, v61
    v_cvt_pk_bf16_f32 v59, v62, v63
    v_mfma_f32_16x16x32_bf16 v[140:143], v[100:103], v[196:199], v[140:143]
    buffer_store_dwordx4 v[56:59], v4, s[24:27], s51 offen offset:3072 sc1
    v_mfma_f32_16x16x32_bf16 v[140:143], v[96:99], v[192:195], v[140:143]
    v_mfma_f32_16x16x32_bf16 v[140:143], v[92:95], v[188:191], v[140:143]
    ds_write_b128 v5, v[56:59] offset:3072
    v_mfma_f32_16x16x32_bf16 v[140:143], v[88:91], v[184:187], v[140:143]
    v_mfma_f32_16x16x32_bf16 v[144:147], v[88:91], v[208:211], 0
    v_mfma_f32_16x16x32_bf16 v[144:147], v[92:95], v[212:215], v[144:147]
    v_mfma_f32_16x16x32_bf16 v[144:147], v[96:99], v[216:219], v[144:147]
    v_mfma_f32_16x16x32_bf16 v[144:147], v[100:103], v[220:223], v[144:147]
    v_mfma_f32_16x16x32_bf16 v[144:147], v[104:107], v[224:227], v[144:147]
    v_mfma_f32_16x16x32_bf16 v[144:147], v[108:111], v[228:231], v[144:147]
    v_mfma_f32_16x16x32_bf16 v[148:151], v[108:111], v[252:255], 0
    v_cvt_pk_bf16_f32 v136, v136, v137
    v_cvt_pk_bf16_f32 v137, v138, v139
    v_mfma_f32_16x16x32_bf16 v[148:151], v[104:107], v[248:251], v[148:151]
    v_cvt_pk_bf16_f32 v138, v140, v141
    v_cvt_pk_bf16_f32 v139, v142, v143
    v_mfma_f32_16x16x32_bf16 v[148:151], v[100:103], v[244:247], v[148:151]
    buffer_store_dwordx4 v[136:139], v4, s[24:27], s52 offen offset:0 sc1
    v_mfma_f32_16x16x32_bf16 v[148:151], v[96:99], v[240:243], v[148:151]
    v_mfma_f32_16x16x32_bf16 v[148:151], v[92:95], v[236:239], v[148:151]
    ds_write_b128 v5, v[136:139] offset:4096
    v_mfma_f32_16x16x32_bf16 v[148:151], v[88:91], v[232:235], v[148:151]
    v_cvt_pk_bf16_f32 v144, v144, v145
    v_cvt_pk_bf16_f32 v145, v146, v147
    s_nop 5
    v_cvt_pk_bf16_f32 v146, v148, v149
    v_cvt_pk_bf16_f32 v147, v150, v151
    buffer_store_dwordx4 v[144:147], v4, s[24:27], s52 offen offset:1024 sc1
    ds_write_b128 v5, v[144:147] offset:5120
    s_mov_b64 exec, 1
    s_waitcnt vmcnt(0) lgkmcnt(0)
    buffer_store_dword v2, v3, s[24:27], s54 offen offset:2048 sc1
    s_barrier
    s_barrier
L_end1:
    s_endpgm
.fill 128, 4, 0xbf800000
L_code_end:
.section .rodata,"a"
.p2align 6
.amdhsa_kernel standalone__gqa_block_cached__near_ridge_kernel
  .amdhsa_next_free_vgpr 256
  .amdhsa_next_free_sgpr 102
  .amdhsa_accum_offset 256
  .amdhsa_group_segment_fixed_size 0
  .amdhsa_kernarg_size 64
  .amdhsa_user_sgpr_count 2
  .amdhsa_user_sgpr_kernarg_segment_ptr 1
  .amdhsa_system_sgpr_workgroup_id_x 1
.end_amdhsa_kernel
```
